```python
import torch

def _softmax(x, axis=-1):
    return torch.softmax(x, dim=axis)
def _gelu(x):
    return torch.nn.functional.gelu(x, approximate="tanh")
def _silu(x):
    return torch.nn.functional.silu(x)
def _sigmoid(x):
    return torch.sigmoid(x)
def _layernorm(x, axis=-1, eps=1e-5):
    m = x.mean(dim=axis, keepdim=True)
    v = x.var(dim=axis, keepdim=True, unbiased=False)
    return (x - m) / torch.sqrt(v + eps)
def _scatter_add(tgt, idx, src, axis=0):
    return tgt.clone().index_add_(axis, idx, src)
def _segment_sum(src, seg, n):
    out = torch.zeros((n,) + src.shape[1:], dtype=src.dtype)
    return out.index_add_(0, seg, src)
def _pad(x, pw):
    flat = tuple(v for pair in reversed(pw) for v in pair)
    return torch.nn.functional.pad(x, flat)

kernel_name = 'gated_mix__ssm_conv_s4__geglu_ffn__prompt'

def setup_inputs():

    _w = (lambda a: (lambda t: t.to(torch.bfloat16) if t.is_floating_point() else t)(torch.as_tensor(a)))
    def _A_setup():
        B, L, D, N = 1, 2048, 512, 128
        A_re = -(lambda _x: torch.exp(torch.as_tensor(_x)))((lambda *s: torch.randn(*s, dtype=torch.bfloat16) * 3.2)(D, N))
        A_im = torch.pi * (lambda *s: torch.randn(*s, dtype=torch.bfloat16) * 0.05)(D, N)
        B_re = (lambda *s: torch.randn(*s, dtype=torch.bfloat16) * 0.1)(D, N)
        B_im = (lambda *s: torch.randn(*s, dtype=torch.bfloat16) * 0.1)(D, N)
        C_re = (lambda *s: torch.randn(*s, dtype=torch.bfloat16) * 0.1)(D, N)
        C_im = (lambda *s: torch.randn(*s, dtype=torch.bfloat16) * 0.1)(D, N)
        log_dt = (lambda *s: torch.randn(*s, dtype=torch.bfloat16) * 0.05)(D) * 0.5 - 4.0
        Dskip = (lambda *s: torch.randn(*s, dtype=torch.bfloat16) * 0.05)(D)
        return {
            "u": _w((lambda *s: torch.randn(*s, dtype=torch.bfloat16) * 0.05)(B, L, D)),
            "A_re": _w(A_re),
            "A_im": _w(A_im),
            "B_re": _w(B_re),
            "B_im": _w(B_im),
            "C_re": _w(C_re),
            "C_im": _w(C_im),
            "log_dt": _w(log_dt),
            "Dskip": _w(Dskip),
        }
    _A_in = _A_setup()

    def _B_setup():
        B, S, D, F = 1, 2048, 512, 1792
        return {
            "x": _w((lambda *s: torch.randn(*s, dtype=torch.bfloat16) * 0.05)(B, S, D)),
            "w_gate": _w((lambda *s: torch.randn(*s, dtype=torch.bfloat16) * 0.05)(D, F)),
            "w_up": _w((lambda *s: torch.randn(*s, dtype=torch.bfloat16) * 0.05)(D, F)),
            "w_down": _w((lambda *s: torch.randn(*s, dtype=torch.bfloat16) * 0.05)(F, D)),
        }
    _B_in = _B_setup()

    return {
        "A_u": _A_in["u"],
        "A_A_re": _A_in["A_re"],
        "A_A_im": _A_in["A_im"],
        "A_B_re": _A_in["B_re"],
        "A_B_im": _A_in["B_im"],
        "A_C_re": _A_in["C_re"],
        "A_C_im": _A_in["C_im"],
        "A_log_dt": _A_in["log_dt"],
        "A_Dskip": _A_in["Dskip"],
        "B_x": _B_in["x"],
        "B_w_gate": _B_in["w_gate"],
        "B_w_up": _B_in["w_up"],
        "B_w_down": _B_in["w_down"],
        "gate_w": _w((lambda *s: torch.randn(*s, dtype=torch.bfloat16) * 0.05)(512) * 16.0),
    }

def reference(A_u, A_A_re, A_A_im, A_B_re, A_B_im, A_C_re, A_C_im, A_log_dt, A_Dskip, B_x, B_w_gate, B_w_up, B_w_down, gate_w):
    def _A_ref(u, A_re, A_im, B_re, B_im, C_re, C_im, log_dt, Dskip):
        Bsz, L, D = u.shape
        dt = torch.exp(log_dt)[:, None]
        A = A_re + 1j * A_im
        Bc = B_re + 1j * B_im
        Cc = C_re + 1j * C_im
        logdA = dt * A
        dB = dt * Bc
        l = (lambda x, dt: x.to(dt))(torch.arange(L), A_re.dtype)
        P = torch.exp(logdA[:, :, None] * l[None, None, :])
        K = torch.einsum("dn,dnl,dn->dl", Cc, P, dB).real
        L2 = 2 * L
        Kp = _pad(K, ((0, 0), (0, L)))
        up = (lambda x, *d: x.permute(*d))(u, 0, 2, 1)
        up = _pad(up, ((0, 0), (0, 0), (0, L)))
        Kf = (lambda x, axes=(-2,-1): torch.fft.rfft2(x.float(), dim=axes))(Kp[:, None, :], axes=(-2, -1))
        Uf = (lambda x, axes=(-2,-1): torch.fft.rfft2(x.float(), dim=axes))(up[:, :, None, :], axes=(-2, -1))
        Yf = Uf * Kf[None, :, :, :]
        y = (lambda x, s, axes=(-2,-1): torch.fft.irfft2(x, s=s, dim=axes).to(torch.bfloat16))(Yf, (1, L2), axes=(-2, -1))[:, :, 0, :L]
        y = (lambda x, *d: x.permute(*d))(y, 0, 2, 1) + u * Dskip[None, None, :]
        return y

    def _B_ref(x, w_gate, w_up, w_down):
        return (_gelu(x @ w_gate) * (x @ w_up)) @ w_down

    x = A_u
    g = _sigmoid((x * gate_w).sum(-1, keepdims=True))
    a = _A_ref(x, A_A_re, A_A_im, A_B_re, A_B_im, A_C_re, A_C_im, A_log_dt, A_Dskip)
    b = _B_ref(x, B_w_gate, B_w_up, B_w_down)
    return g * a + (1 - g) * b
```

```asm
; @launch grid=(256,1,1) block=(512,1,1) lds=163840
.amdgcn_target "amdgcn-amd-amdhsa--gfx950"
.text
.globl gated_mix__ssm_conv_s4__geglu_ffn__prompt_kernel
.p2align 8
.type gated_mix__ssm_conv_s4__geglu_ffn__prompt_kernel,@function
gated_mix__ssm_conv_s4__geglu_ffn__prompt_kernel:
    s_cmp_ge_u32 s2, 256
    s_cbranch_scc1 Lend
    v_lshrrev_b32 v1, 6, v0
    s_load_dwordx16 s[16:31], s[0:1], 0
    s_load_dwordx16 s[32:47], s[0:1], 64
    s_load_dwordx2 s[48:49], s[0:1], 128
    v_readfirstlane_b32 s3, v1
    s_nop 1
    s_cmp_lt_u32 s3, 4
    s_cbranch_scc1 Lcompute
    s_cmp_lt_u32 s2, 248
    s_cbranch_scc1 Lcp
    s_getpc_b64 s[8:9]
Lpc:
    s_sub_u32 s8, s8, Lpc-gated_mix__ssm_conv_s4__geglu_ffn__prompt_kernel
    s_subb_u32 s9, s9, 0
    v_and_b32 v5, 0xff, v0
    v_lshlrev_b32 v5, 7, v5
    v_min_u32 v5, Lcodeend-gated_mix__ssm_conv_s4__geglu_ffn__prompt_kernel-4, v5
    s_nop 0
    global_load_dword a94, v5, s[8:9]
Lcp:
    v_and_b32 v0, 63, v0
    s_and_b32 s76, s2, 7
    s_lshr_b32 s77, s2, 3
    s_lshr_b32 s80, s76, 1
    s_mul_i32 s80, s80, 28
    s_add_u32 s80, s80, s77
    s_lshr_b32 s89, s80, 3
    s_and_b32 s80, s80, 7
    s_and_b32 s81, s76, 1
    s_lshl_b32 s81, s81, 3
    s_add_u32 s88, s80, s81
    s_mul_i32 s80, s77, 37
    s_lshr_b32 s80, s80, 8
    s_mul_i32 s81, s80, 7
    s_sub_u32 s81, s77, s81
    s_cmp_ge_u32 s81, 3
    s_addc_u32 s98, s81, 0
    s_cmp_ge_u32 s77, 28
    s_cselect_b32 s98, 3, s98
    s_cselect_b32 s80, s81, s80
    s_lshl_b32 s97, s76, 2
    s_add_u32 s97, s97, s80
    s_and_b32 s78, s3, 3
    s_lshl_b32 s80, s76, 6
    s_lshl_b32 s81, s77, 1
    s_add_u32 s80, s80, s81
    s_lshr_b32 s81, s78, 1
    s_add_u32 s79, s80, s81
    s_lshl_b32 s80, s79, 8
    s_and_b32 s81, s78, 1
    s_lshl_b32 s81, s81, 7
    s_add_u32 s80, s80, s81
    v_lshlrev_b32 v32, 1, v0
    v_add_u32 v32, s80, v32
    s_lshl_b32 s80, s79, 1
    v_mov_b32 v63, s80
    s_lshr_b32 s80, s78, 1
    s_mul_i32 s80, s80, 28672
    s_and_b32 s81, s78, 1
    s_mul_i32 s81, s81, 7168
    s_add_u32 s80, s80, s81
    s_add_u32 s80, s80, 98304
    v_mul_u32_u24 v62, 112, v0
    v_add_u32 v62, s80, v62
    s_setprio 0
    v_lshrrev_b32 v4, 3, v0
    v_lshlrev_b32 v4, 10, v4
    v_and_b32 v5, 7, v0
    v_lshrrev_b32 v6, 4, v0
    v_xor_b32 v7, v5, v6
    v_lshlrev_b32 v7, 4, v7
    v_add_u32 v2, v4, v7
    v_xor_b32 v3, 64, v2
    s_lshl_b32 s90, s88, 17
    s_lshl_b32 s80, s78, 15
    s_add_u32 s90, s90, s80
    v_and_b32 v5, 15, v0
    v_lshlrev_b32 v7, 2, v6
    v_xor_b32 v5, v5, v7
    v_lshlrev_b32 v5, 4, v5
    v_mul_u32_u24 v6, 3584, v6
    v_add_u32 v4, v6, v5
    v_xor_b32 v29, 32, v4
    s_lshl_b32 s91, s89, 8
    s_mul_i32 s80, s78, 57344
    s_add_u32 s91, s91, s80
    s_lshl_b32 s92, s78, 12
    s_add_u32 s14, s88, s89
    s_and_b32 s14, s14, 3
    s_lshl_b32 s14, s14, 1
    s_add_u32 s14, s14, 0
    s_waitcnt lgkmcnt(0)
    s_cmp_ge_u32 s77, 28
    s_cbranch_scc1 Lhidle
    s_mov_b32 s56, s36
    s_and_b32 s57, s37, 0xffff
    s_mov_b32 s58, 0x1c0000
    s_mov_b32 s59, 0x20000
    s_mov_b32 s60, s38
    s_and_b32 s61, s39, 0xffff
    s_mov_b32 s62, 0x1c0000
    s_mov_b32 s63, 0x20000
    s_mov_b32 s52, s16
    s_and_b32 s53, s17, 0xffff
    s_mov_b32 s54, 0x200000
    s_mov_b32 s55, 0x20000
    s_add_u32 s9, s14, 0
    s_and_b32 s9, s9, 7
    s_lshl_b32 s35, s9, 7
    s_add_u32 s35, s35, s90
    s_mul_i32 s8, s9, 229376
    s_add_u32 s8, s8, s91
    s_add_u32 m0, s92, 0
    s_add_u32 s93, s35, 0
    buffer_load_dwordx4 v2, s[52:55], s93 offen lds
    s_add_u32 m0, s92, 16384
    s_add_u32 s93, s8, 0
    buffer_load_dwordx4 v4, s[56:59], s93 offen lds
    s_add_u32 m0, s92, 32768
    s_nop 0
    buffer_load_dwordx4 v4, s[60:63], s93 offen lds
    s_add_u32 m0, s92, 1024
    s_add_u32 s93, s35, 8192
    buffer_load_dwordx4 v3, s[52:55], s93 offen lds
    s_add_u32 m0, s92, 17408
    s_add_u32 s93, s8, 14336
    buffer_load_dwordx4 v4, s[56:59], s93 offen lds
    s_add_u32 m0, s92, 33792
    s_nop 0
    buffer_load_dwordx4 v4, s[60:63], s93 offen lds
    s_add_u32 m0, s92, 2048
    s_add_u32 s93, s35, 16384
    buffer_load_dwordx4 v2, s[52:55], s93 offen lds
    s_add_u32 m0, s92, 18432
    s_add_u32 s93, s8, 28672
    buffer_load_dwordx4 v29, s[56:59], s93 offen lds
    s_add_u32 m0, s92, 34816
    s_nop 0
    buffer_load_dwordx4 v29, s[60:63], s93 offen lds
    s_add_u32 m0, s92, 3072
    s_add_u32 s93, s35, 24576
    buffer_load_dwordx4 v3, s[52:55], s93 offen lds
    s_add_u32 m0, s92, 19456
    s_add_u32 s93, s8, 43008
    buffer_load_dwordx4 v29, s[56:59], s93 offen lds
    s_add_u32 m0, s92, 35840
    s_nop 0
    buffer_load_dwordx4 v29, s[60:63], s93 offen lds
    s_add_u32 s50, s48, 0xe10000
    s_addc_u32 s51, s49, 0
    s_load_dword s96, s[50:51], 0
    s_mov_b32 s68, s48
    s_and_b32 s69, s49, 0xffff
    s_mov_b32 s70, 0x10000000
    s_mov_b32 s71, 0x20000
    s_waitcnt lgkmcnt(0)
    s_mov_b32 s64, s40
    s_and_b32 s65, s41, 0xffff
    s_mov_b32 s66, 0x1c0000
    s_mov_b32 s67, 0x20000
    s_mov_b32 s72, s44
    s_and_b32 s73, s45, 0xffff
    s_mov_b32 s74, 0x200000
    s_mov_b32 s75, 0x20000
    s_add_u32 s9, s14, 1
    s_and_b32 s9, s9, 7
    s_lshl_b32 s35, s9, 7
    s_add_u32 s35, s35, s90
    s_mul_i32 s8, s9, 229376
    s_add_u32 s8, s8, s91
    s_add_u32 m0, s92, 49152
    s_add_u32 s93, s35, 0
    buffer_load_dwordx4 v2, s[52:55], s93 offen lds
    s_lshl_b32 s80, s78, 9
    v_lshlrev_b32 v152, 3, v0
    v_add_u32 v152, s80, v152
    v_add_u32 v153, 7, v152
    v_cvt_f32_u32 v154, v153
    v_cvt_pk_bf16_f32 v154, v154, v154
    v_and_b32 v154, 0xffff, v154
    v_subrev_u32 v154, 0x4280, v154
    s_add_u32 m0, s92, 65536
    s_add_u32 s93, s8, 0
    buffer_load_dwordx4 v4, s[56:59], s93 offen lds
    v_cmp_gt_u32 vcc, 0x80, v153
    s_nop 1
    v_cndmask_b32 v154, v154, v153, vcc
    v_lshlrev_b32 v154, 1, v154
    v_add_u32 v144, 0x27400, v154
    v_add_u32 v153, 6, v152
    v_cvt_f32_u32 v154, v153
    v_cvt_pk_bf16_f32 v154, v154, v154
    v_and_b32 v154, 0xffff, v154
    s_add_u32 m0, s92, 81920
    s_nop 0
    buffer_load_dwordx4 v4, s[60:63], s93 offen lds
    v_subrev_u32 v154, 0x4280, v154
    v_cmp_gt_u32 vcc, 0x80, v153
    s_nop 1
    v_cndmask_b32 v154, v154, v153, vcc
    v_lshlrev_b32 v154, 1, v154
    v_add_u32 v145, 0x27400, v154
    v_add_u32 v153, 5, v152
    v_cvt_f32_u32 v154, v153
    v_cvt_pk_bf16_f32 v154, v154, v154
    s_add_u32 m0, s92, 50176
    s_add_u32 s93, s35, 8192
    buffer_load_dwordx4 v3, s[52:55], s93 offen lds
    v_and_b32 v154, 0xffff, v154
    v_subrev_u32 v154, 0x4280, v154
    v_cmp_gt_u32 vcc, 0x80, v153
    s_nop 1
    v_cndmask_b32 v154, v154, v153, vcc
    v_lshlrev_b32 v154, 1, v154
    v_add_u32 v146, 0x27400, v154
    v_add_u32 v153, 4, v152
    v_cvt_f32_u32 v154, v153
    s_add_u32 m0, s92, 66560
    s_add_u32 s93, s8, 14336
    buffer_load_dwordx4 v4, s[56:59], s93 offen lds
    v_cvt_pk_bf16_f32 v154, v154, v154
    v_and_b32 v154, 0xffff, v154
    v_subrev_u32 v154, 0x4280, v154
    v_cmp_gt_u32 vcc, 0x80, v153
    s_nop 1
    v_cndmask_b32 v154, v154, v153, vcc
    v_lshlrev_b32 v154, 1, v154
    v_add_u32 v147, 0x27400, v154
    v_add_u32 v153, 3, v152
    s_add_u32 m0, s92, 82944
    s_nop 0
    buffer_load_dwordx4 v4, s[60:63], s93 offen lds
    v_cvt_f32_u32 v154, v153
    v_cvt_pk_bf16_f32 v154, v154, v154
    v_and_b32 v154, 0xffff, v154
    v_subrev_u32 v154, 0x4280, v154
    v_cmp_gt_u32 vcc, 0x80, v153
    s_nop 1
    v_cndmask_b32 v154, v154, v153, vcc
    v_lshlrev_b32 v154, 1, v154
    v_add_u32 v148, 0x27400, v154
    s_add_u32 m0, s92, 51200
    s_add_u32 s93, s35, 16384
    buffer_load_dwordx4 v2, s[52:55], s93 offen lds
    v_add_u32 v153, 2, v152
    v_cvt_f32_u32 v154, v153
    v_cvt_pk_bf16_f32 v154, v154, v154
    v_and_b32 v154, 0xffff, v154
    v_subrev_u32 v154, 0x4280, v154
    v_cmp_gt_u32 vcc, 0x80, v153
    s_nop 1
    v_cndmask_b32 v154, v154, v153, vcc
    v_lshlrev_b32 v154, 1, v154
    s_add_u32 m0, s92, 67584
    s_add_u32 s93, s8, 28672
    buffer_load_dwordx4 v29, s[56:59], s93 offen lds
    v_add_u32 v149, 0x27400, v154
    v_add_u32 v153, 1, v152
    v_cvt_f32_u32 v154, v153
    v_cvt_pk_bf16_f32 v154, v154, v154
    v_and_b32 v154, 0xffff, v154
    v_subrev_u32 v154, 0x4280, v154
    v_cmp_gt_u32 vcc, 0x80, v153
    s_nop 1
    v_cndmask_b32 v154, v154, v153, vcc
    s_add_u32 m0, s92, 83968
    s_nop 0
    buffer_load_dwordx4 v29, s[60:63], s93 offen lds
    v_lshlrev_b32 v154, 1, v154
    v_add_u32 v150, 0x27400, v154
    v_add_u32 v153, 0, v152
    v_cvt_f32_u32 v154, v153
    v_cvt_pk_bf16_f32 v154, v154, v154
    v_and_b32 v154, 0xffff, v154
    v_subrev_u32 v154, 0x4280, v154
    v_cmp_gt_u32 vcc, 0x80, v153
    s_add_u32 m0, s92, 52224
    s_add_u32 s93, s35, 24576
    buffer_load_dwordx4 v3, s[52:55], s93 offen lds
    v_cndmask_b32 v154, v154, v153, vcc
    v_lshlrev_b32 v154, 1, v154
    v_add_u32 v151, 0x27400, v154
    v_lshrrev_b32 v153, 4, v152
    v_lshlrev_b32 v153, 4, v153
    v_and_b32 v154, 1, v0
    v_mul_u32_u24 v154, 2304, v154
    v_add_u32 v153, v153, v154
    s_add_u32 m0, s92, 68608
    s_add_u32 s93, s8, 43008
    buffer_load_dwordx4 v29, s[56:59], s93 offen lds
    v_add_u32 v26, 0x25d00, v153
    v_lshrrev_b32 v153, 4, v0
    v_mul_u32_u24 v153, 2304, v153
    v_and_b32 v154, 15, v0
    v_lshlrev_b32 v154, 4, v154
    v_add_u32 v153, v153, v154
    v_add_u32 v27, 0x25c00, v153
    s_add_u32 m0, s92, 84992
    s_nop 0
    buffer_load_dwordx4 v29, s[60:63], s93 offen lds
    s_lshl_b32 s80, s2, 2
    s_add_u32 s80, s80, s78
    s_lshl_b32 s80, s80, 11
    v_lshlrev_b32 v7, 7, v0
    s_mov_b64 exec, 0xffff
    buffer_load_dword v159, v7, s[64:67], s80 offen
    s_mov_b64 exec, -1
    s_mul_i32 s96, s96, 0x9E3779B1
    s_add_u32 s96, s96, 0x7F4A7C15
    s_waitcnt vmcnt(13)
    s_barrier
    s_add_u32 s9, s14, 2
    s_and_b32 s9, s9, 7
    s_lshl_b32 s35, s9, 7
    s_add_u32 s35, s35, s90
    s_mul_i32 s8, s9, 229376
    s_add_u32 s8, s8, s91
    s_add_u32 m0, s92, 98304
    s_add_u32 s93, s35, 0
    buffer_load_dwordx4 v2, s[52:55], s93 offen lds
    ds_read_u16 v64, v144 offset:0
    ds_read_u16 v65, v145 offset:0
    ds_read_u16 v66, v146 offset:0
    s_add_u32 m0, s92, 114688
    s_add_u32 s93, s8, 0
    buffer_load_dwordx4 v4, s[56:59], s93 offen lds
    ds_read_u16 v67, v147 offset:0
    ds_read_u16 v68, v148 offset:0
    ds_read_u16 v69, v149 offset:0
    s_add_u32 m0, s92, 131072
    s_nop 0
    buffer_load_dwordx4 v4, s[60:63], s93 offen lds
    ds_read_u16 v70, v150 offset:0
    ds_read_u16 v71, v151 offset:0
    ds_read_u16 v72, v144 offset:1536
    s_add_u32 m0, s92, 99328
    s_add_u32 s93, s35, 8192
    buffer_load_dwordx4 v3, s[52:55], s93 offen lds
    ds_read_u16 v73, v145 offset:1536
    ds_read_u16 v74, v146 offset:1536
    ds_read_u16 v75, v147 offset:1536
    s_add_u32 m0, s92, 115712
    s_add_u32 s93, s8, 14336
    buffer_load_dwordx4 v4, s[56:59], s93 offen lds
    ds_read_u16 v76, v148 offset:1536
    ds_read_u16 v77, v149 offset:1536
    ds_read_u16 v78, v150 offset:1536
    s_add_u32 m0, s92, 132096
    s_nop 0
    buffer_load_dwordx4 v4, s[60:63], s93 offen lds
    ds_read_u16 v79, v151 offset:1536
    s_waitcnt lgkmcnt(14)
    v_lshl_or_b32 v52, v65, 16, v64
    s_waitcnt lgkmcnt(12)
    v_lshl_or_b32 v53, v67, 16, v66
    s_add_u32 m0, s92, 100352
    s_add_u32 s93, s35, 16384
    buffer_load_dwordx4 v2, s[52:55], s93 offen lds
    s_waitcnt lgkmcnt(10)
    v_lshl_or_b32 v54, v69, 16, v68
    s_waitcnt lgkmcnt(8)
    v_lshl_or_b32 v55, v71, 16, v70
    s_waitcnt lgkmcnt(6)
    v_lshl_or_b32 v56, v73, 16, v72
    s_add_u32 m0, s92, 116736
    s_add_u32 s93, s8, 28672
    buffer_load_dwordx4 v29, s[56:59], s93 offen lds
    s_waitcnt lgkmcnt(4)
    v_lshl_or_b32 v57, v75, 16, v74
    s_waitcnt lgkmcnt(2)
    v_lshl_or_b32 v58, v77, 16, v76
    s_waitcnt lgkmcnt(0)
    v_lshl_or_b32 v59, v79, 16, v78
    s_add_u32 m0, s92, 133120
    s_nop 0
    buffer_load_dwordx4 v29, s[60:63], s93 offen lds
    v_mov_b32 v64, 0
    v_mov_b32 v65, 0
    v_mov_b32 v66, 0
    s_add_u32 m0, s92, 101376
    s_add_u32 s93, s35, 24576
    buffer_load_dwordx4 v3, s[52:55], s93 offen lds
    v_mov_b32 v67, 0
    s_add_u32 m0, s92, 117760
    s_add_u32 s93, s8, 43008
    buffer_load_dwordx4 v29, s[56:59], s93 offen lds
    s_add_u32 m0, s92, 134144
    s_nop 0
    buffer_load_dwordx4 v29, s[60:63], s93 offen lds
    s_waitcnt vmcnt(13)
    s_barrier
    s_add_u32 s9, s14, 3
    s_and_b32 s9, s9, 7
    s_lshl_b32 s35, s9, 7
    s_add_u32 s35, s35, s90
    s_mul_i32 s8, s9, 229376
    s_add_u32 s8, s8, s91
    s_add_u32 m0, s92, 0
    s_add_u32 s93, s35, 0
    buffer_load_dwordx4 v2, s[52:55], s93 offen lds
    ds_write_b128 v27, v[64:67]
    ds_write_b128 v26, v[52:55] offset:0
    ds_write_b128 v26, v[56:59] offset:4608
    s_mul_i32 s85, s79, 4224
    s_add_u32 m0, s92, 16384
    s_add_u32 s93, s8, 0
    buffer_load_dwordx4 v4, s[56:59], s93 offen lds
    s_and_b32 s81, s78, 1
    s_lshl_b32 s80, s81, 11
    s_add_u32 s85, s85, s80
    s_add_u32 s85, s85, 0x1400000
    s_add_u32 m0, s92, 32768
    s_nop 0
    buffer_load_dwordx4 v4, s[60:63], s93 offen lds
    s_lshr_b32 s82, s78, 1
    s_mul_i32 s83, s82, 4352
    s_add_u32 s83, s83, 16640
    s_add_u32 s86, s83, s80
    s_add_u32 m0, s92, 1024
    s_add_u32 s93, s35, 8192
    buffer_load_dwordx4 v3, s[52:55], s93 offen lds
    s_add_u32 s86, s86, 64
    v_lshlrev_b32 v28, 2, v0
    v_add_u32 v22, s83, v28
    s_lshl_b32 s80, s81, 8
    s_add_u32 m0, s92, 17408
    s_add_u32 s93, s8, 14336
    buffer_load_dwordx4 v4, s[56:59], s93 offen lds
    s_add_u32 s80, s80, s83
    s_add_u32 s80, s80, 28
    v_add_u32 v28, s80, v28
    s_lshl_b32 s81, s81, 10
    s_add_u32 m0, s92, 33792
    s_nop 0
    buffer_load_dwordx4 v4, s[60:63], s93 offen lds
    s_mul_i32 s80, s82, 33536
    s_add_u32 s80, s80, 98304
    s_add_u32 s80, s80, s81
    v_lshlrev_b32 v20, 4, v0
    s_add_u32 m0, s92, 2048
    s_add_u32 s93, s35, 16384
    buffer_load_dwordx4 v2, s[52:55], s93 offen lds
    v_add_u32 v21, s80, v20
    s_mul_i32 s80, s82, 114944
    s_sub_u32 s80, 115072, s80
    s_add_u32 s80, s80, s81
    s_add_u32 m0, s92, 18432
    s_add_u32 s93, s8, 28672
    buffer_load_dwordx4 v29, s[56:59], s93 offen lds
    v_add_u32 v20, s80, v20
    s_add_u32 m0, s92, 34816
    s_nop 0
    buffer_load_dwordx4 v29, s[60:63], s93 offen lds
    v_lshrrev_b32 v5, 3, v0
    v_lshlrev_b32 v5, 10, v5
    v_bfe_u32 v6, v0, 4, 1
    v_lshlrev_b32 v6, 2, v6
    v_and_b32 v7, 7, v0
    v_xor_b32 v6, v6, v7
    v_lshlrev_b32 v6, 4, v6
    v_add_u32 v30, v5, v6
    s_mul_i32 s94, s78, 458752
    s_lshl_b32 s80, s98, 7
    s_add_u32 s94, s94, s80
    s_waitcnt lgkmcnt(0)
    s_mov_b32 s18, 0
    s_mov_b32 s19, 1
    s_mov_b32 s20, 2
    s_mov_b32 s21, 3
    s_mov_b32 s22, 4
    s_mov_b32 s23, 5
    s_mov_b32 s24, 6
    s_lshl_b32 s95, s78, 14
    s_add_u32 s95, s95, 32768
    s_lshl_b32 s25, s78, 13
    s_waitcnt vmcnt(9)
    s_barrier
    s_add_u32 m0, s92, 3072
    s_add_u32 s93, s35, 24576
    buffer_load_dwordx4 v3, s[52:55], s93 offen lds
    s_add_u32 m0, s92, 19456
    s_add_u32 s93, s8, 43008
    buffer_load_dwordx4 v29, s[56:59], s93 offen lds
    s_add_u32 m0, s92, 35840
    s_nop 0
    buffer_load_dwordx4 v29, s[60:63], s93 offen lds
    s_add_u32 s9, s14, 4
    s_and_b32 s9, s9, 7
    s_lshl_b32 s35, s9, 7
    s_add_u32 s35, s35, s90
    s_mul_i32 s8, s9, 229376
    s_add_u32 s8, s8, s91
    s_add_u32 m0, s92, 49152
    s_add_u32 s93, s35, 0
    buffer_load_dwordx4 v2, s[52:55], s93 offen lds
    s_add_u32 m0, s92, 65536
    s_add_u32 s93, s8, 0
    buffer_load_dwordx4 v4, s[56:59], s93 offen lds
    s_add_u32 m0, s92, 81920
    s_nop 0
    buffer_load_dwordx4 v4, s[60:63], s93 offen lds
    s_add_u32 m0, s92, 50176
    s_add_u32 s93, s35, 8192
    buffer_load_dwordx4 v3, s[52:55], s93 offen lds
    s_add_u32 m0, s92, 66560
    s_add_u32 s93, s8, 14336
    buffer_load_dwordx4 v4, s[56:59], s93 offen lds
    s_add_u32 m0, s92, 82944
    s_nop 0
    buffer_load_dwordx4 v4, s[60:63], s93 offen lds
    s_add_u32 m0, s92, 51200
    s_add_u32 s93, s35, 16384
    buffer_load_dwordx4 v2, s[52:55], s93 offen lds
    s_add_u32 m0, s92, 67584
    s_add_u32 s93, s8, 28672
    buffer_load_dwordx4 v29, s[56:59], s93 offen lds
    s_add_u32 m0, s92, 83968
    s_nop 0
    buffer_load_dwordx4 v29, s[60:63], s93 offen lds
    s_add_u32 m0, s92, 52224
    s_add_u32 s93, s35, 24576
    buffer_load_dwordx4 v3, s[52:55], s93 offen lds
    s_add_u32 m0, s92, 68608
    s_add_u32 s93, s8, 43008
    buffer_load_dwordx4 v29, s[56:59], s93 offen lds
    s_add_u32 m0, s92, 84992
    s_nop 0
    buffer_load_dwordx4 v29, s[60:63], s93 offen lds
    s_lshr_b32 s80, s78, 1
    s_and_b32 s82, s78, 1
    s_mul_i32 s81, s80, 33536
    s_add_u32 s81, s81, 98304
    s_mul_i32 s83, s80, 114944
    s_sub_u32 s83, 115072, s83
    v_bfe_u32 v5, v0, 4, 1
    v_lshlrev_b32 v5, 1, v5
    v_lshrrev_b32 v6, 5, v0
    v_add_u32 v5, v5, v6
    v_bfe_u32 v6, v0, 1, 3
    v_lshlrev_b32 v7, 2, v5
    v_sub_u32 v7, v6, v7
    v_add_u32 v7, 13, v7
    v_lshlrev_b32 v7, 4, v7
    v_mov_b32 v8, s81
    v_mov_b32 v9, s83
    v_and_b32 v6, 1, v0
    v_cmp_eq_u32 vcc, 1, v6
    s_nop 1
    v_cndmask_b32 v8, v8, v9, vcc
    v_add_u32 v8, v8, v7
    s_lshl_b32 s81, s82, 10
    v_add_u32 v8, s81, v8
    v_and_b32 v6, 15, v0
    v_lshrrev_b32 v7, 5, v0
    v_mul_u32_u24 v7, 2304, v7
    v_bfe_u32 v9, v0, 4, 1
    v_add_u32 v9, v9, v6
    v_lshlrev_b32 v9, 4, v9
    v_add_u32 v7, v7, v9
    s_mul_i32 s81, s80, 4608
    s_lshl_b32 s83, s82, 7
    s_sub_u32 s83, s81, s83
    s_add_u32 s83, s83, 154768
    v_add_u32 v9, s83, v7
    v_lshlrev_b32 v10, 4, v0
    s_lshl_b32 s81, s78, 12
    s_add_u32 s81, s81, 16640
    s_cmp_eq_u32 s78, 3
    s_cselect_b32 s81, 148480, s81
    v_add_u32 v12, s81, v10
    s_xor_b32 s83, s78, 1
    s_lshl_b32 s81, s83, 12
    s_add_u32 s81, s81, 16640
    s_cmp_eq_u32 s83, 3
    s_cselect_b32 s81, 148480, s81
    v_add_u32 v11, s81, v10
    v_and_b32 v15, 15, v0
    v_lshlrev_b32 v15, 5, v15
    v_lshrrev_b32 v14, 4, v0
    v_lshlrev_b32 v14, 3, v14
    v_add_u32 v15, v15, v14
    s_lshl_b32 s81, s78, 12
    s_add_u32 s81, s81, 0
    v_add_u32 v15, s81, v15
    v_add_u32 v14, s81, v10
    s_waitcnt vmcnt(12)
    s_barrier
    s_add_u32 s9, s14, 5
    s_and_b32 s9, s9, 7
    s_lshl_b32 s35, s9, 7
    s_add_u32 s35, s35, s90
    s_mul_i32 s8, s9, 229376
    s_add_u32 s8, s8, s91
    s_add_u32 m0, s92, 98304
    s_add_u32 s93, s35, 0
    buffer_load_dwordx4 v2, s[52:55], s93 offen lds
    s_add_u32 m0, s92, 114688
    s_add_u32 s93, s8, 0
    buffer_load_dwordx4 v4, s[56:59], s93 offen lds
    s_add_u32 m0, s92, 131072
    s_nop 0
    buffer_load_dwordx4 v4, s[60:63], s93 offen lds
    s_add_u32 m0, s92, 99328
    s_add_u32 s93, s35, 8192
    buffer_load_dwordx4 v3, s[52:55], s93 offen lds
    s_add_u32 m0, s92, 115712
    s_add_u32 s93, s8, 14336
    buffer_load_dwordx4 v4, s[56:59], s93 offen lds
    s_add_u32 m0, s92, 132096
    s_nop 0
    buffer_load_dwordx4 v4, s[60:63], s93 offen lds
    s_add_u32 m0, s92, 100352
    s_add_u32 s93, s35, 16384
    buffer_load_dwordx4 v2, s[52:55], s93 offen lds
    s_add_u32 m0, s92, 116736
    s_add_u32 s93, s8, 28672
    buffer_load_dwordx4 v29, s[56:59], s93 offen lds
    s_add_u32 m0, s92, 133120
    s_nop 0
    buffer_load_dwordx4 v29, s[60:63], s93 offen lds
    s_add_u32 m0, s92, 101376
    s_add_u32 s93, s35, 24576
    buffer_load_dwordx4 v3, s[52:55], s93 offen lds
    s_add_u32 m0, s92, 117760
    s_add_u32 s93, s8, 43008
    buffer_load_dwordx4 v29, s[56:59], s93 offen lds
    s_add_u32 m0, s92, 134144
    s_nop 0
    buffer_load_dwordx4 v29, s[60:63], s93 offen lds
    s_lshl_b32 s26, s23, 16
    s_add_u32 s26, s26, s94
    buffer_load_dwordx4 v[64:67], v30, s[64:67], s26 offen
    s_add_u32 s26, s26, 16384
    buffer_load_dwordx4 v[68:71], v30, s[64:67], s26 offen
    s_add_u32 s26, s26, 4294959104
    buffer_load_dwordx4 v[72:75], v30, s[64:67], s26 offen
    s_add_u32 s26, s26, 16384
    buffer_load_dwordx4 v[76:79], v30, s[64:67], s26 offen
    s_lshl_b32 s26, s23, 16
    s_add_u32 s26, s26, s94
    s_add_u32 s26, s26, 0x8000
    buffer_load_dwordx4 v[80:83], v30, s[64:67], s26 offen
    s_waitcnt vmcnt(17)
    s_barrier
    s_add_u32 s9, s14, 6
    s_and_b32 s9, s9, 7
    s_lshl_b32 s35, s9, 7
    s_add_u32 s35, s35, s90
    s_mul_i32 s8, s9, 229376
    s_add_u32 s8, s8, s91
    s_add_u32 m0, s92, 0
    s_add_u32 s93, s35, 0
    buffer_load_dwordx4 v2, s[52:55], s93 offen lds
    s_add_u32 m0, s92, 16384
    s_add_u32 s93, s8, 0
    buffer_load_dwordx4 v4, s[56:59], s93 offen lds
    s_add_u32 m0, s92, 32768
    s_nop 0
    buffer_load_dwordx4 v4, s[60:63], s93 offen lds
    s_add_u32 m0, s92, 1024
    s_add_u32 s93, s35, 8192
    buffer_load_dwordx4 v3, s[52:55], s93 offen lds
    s_add_u32 m0, s92, 17408
    s_add_u32 s93, s8, 14336
    buffer_load_dwordx4 v4, s[56:59], s93 offen lds
    s_add_u32 m0, s92, 33792
    s_nop 0
    buffer_load_dwordx4 v4, s[60:63], s93 offen lds
    s_add_u32 m0, s92, 2048
    s_add_u32 s93, s35, 16384
    buffer_load_dwordx4 v2, s[52:55], s93 offen lds
    s_add_u32 m0, s92, 18432
    s_add_u32 s93, s8, 28672
    buffer_load_dwordx4 v29, s[56:59], s93 offen lds
    s_add_u32 m0, s92, 34816
    s_nop 0
    buffer_load_dwordx4 v29, s[60:63], s93 offen lds
    s_add_u32 m0, s92, 3072
    s_add_u32 s93, s35, 24576
    buffer_load_dwordx4 v3, s[52:55], s93 offen lds
    s_add_u32 m0, s92, 19456
    s_add_u32 s93, s8, 43008
    buffer_load_dwordx4 v29, s[56:59], s93 offen lds
    s_add_u32 m0, s92, 35840
    s_nop 0
    buffer_load_dwordx4 v29, s[60:63], s93 offen lds
    s_add_u32 s26, s26, 16384
    buffer_load_dwordx4 v[84:87], v30, s[64:67], s26 offen
    s_add_u32 s26, s26, 4294959104
    buffer_load_dwordx4 v[88:91], v30, s[64:67], s26 offen
    s_add_u32 s26, s26, 16384
    buffer_load_dwordx4 v[92:95], v30, s[64:67], s26 offen
    s_lshl_b32 s26, s24, 16
    s_add_u32 s26, s26, s94
    buffer_load_dwordx4 v[96:99], v30, s[64:67], s26 offen
    s_add_u32 s26, s26, 16384
    buffer_load_dwordx4 v[100:103], v30, s[64:67], s26 offen
    s_lshl_b32 s84, s76, 9
    s_add_u32 s84, s84, 0xe20000
    s_lshl_b32 s80, s98, 9
    s_add_u32 s80, s80, 0xe80000
    v_bfe_u32 v24, v0, 3, 2
    v_lshlrev_b32 v24, 7, v24
    v_and_b32 v25, 7, v0
    v_lshlrev_b32 v25, 2, v25
    v_add_u32 v24, v24, v25
    v_and_b32 v25, 0x18c, v24
    v_add_u32 v25, s80, v25
    v_add_u32 v24, s84, v24
    v_cmp_lt_u32 vcc, 31, v0
    s_nop 1
    v_cndmask_b32 v24, v24, v25, vcc
    s_mov_b32 s84, 0
    s_waitcnt vmcnt(22)
    s_barrier
    s_add_u32 s9, s14, 7
    s_and_b32 s9, s9, 7
    s_lshl_b32 s35, s9, 7
    s_add_u32 s35, s35, s90
    s_mul_i32 s8, s9, 229376
    s_add_u32 s8, s8, s91
    s_add_u32 m0, s92, 49152
    s_add_u32 s93, s35, 0
    buffer_load_dwordx4 v2, s[52:55], s93 offen lds
    s_add_u32 m0, s92, 65536
    s_add_u32 s93, s8, 0
    buffer_load_dwordx4 v4, s[56:59], s93 offen lds
    s_add_u32 m0, s92, 81920
    s_nop 0
    buffer_load_dwordx4 v4, s[60:63], s93 offen lds
    s_add_u32 m0, s92, 50176
    s_add_u32 s93, s35, 8192
    buffer_load_dwordx4 v3, s[52:55], s93 offen lds
    s_add_u32 m0, s92, 66560
    s_add_u32 s93, s8, 14336
    buffer_load_dwordx4 v4, s[56:59], s93 offen lds
    s_add_u32 m0, s92, 82944
    s_nop 0
    buffer_load_dwordx4 v4, s[60:63], s93 offen lds
    s_add_u32 m0, s92, 51200
    s_add_u32 s93, s35, 16384
    buffer_load_dwordx4 v2, s[52:55], s93 offen lds
    s_add_u32 m0, s92, 67584
    s_add_u32 s93, s8, 28672
    buffer_load_dwordx4 v29, s[56:59], s93 offen lds
    s_add_u32 m0, s92, 83968
    s_nop 0
    buffer_load_dwordx4 v29, s[60:63], s93 offen lds
    s_add_u32 m0, s92, 52224
    s_add_u32 s93, s35, 24576
    buffer_load_dwordx4 v3, s[52:55], s93 offen lds
    s_add_u32 m0, s92, 68608
    s_add_u32 s93, s8, 43008
    buffer_load_dwordx4 v29, s[56:59], s93 offen lds
    s_add_u32 m0, s92, 84992
    s_nop 0
    buffer_load_dwordx4 v29, s[60:63], s93 offen lds
    s_add_u32 s26, s26, 4294959104
    buffer_load_dwordx4 v[104:107], v30, s[64:67], s26 offen
    s_add_u32 s26, s26, 16384
    buffer_load_dwordx4 v[108:111], v30, s[64:67], s26 offen
    s_lshl_b32 s26, s24, 16
    s_add_u32 s26, s26, s94
    s_add_u32 s26, s26, 0x8000
    buffer_load_dwordx4 v[112:115], v30, s[64:67], s26 offen
    s_add_u32 s26, s26, 16384
    buffer_load_dwordx4 v[116:119], v30, s[64:67], s26 offen
    s_add_u32 s26, s26, 4294959104
    buffer_load_dwordx4 v[120:123], v30, s[64:67], s26 offen
    s_waitcnt vmcnt(22)
    s_barrier
    s_cmp_lg_u32 s78, 0
    s_cbranch_scc1 Lq_1001
    buffer_load_dword v25, v24, s[68:71], s84 offen sc1
Lq_1001:
    s_add_u32 s26, s26, 16384
    buffer_load_dwordx4 v[124:127], v30, s[64:67], s26 offen
    s_lshl_b32 s26, s21, 16
    s_add_u32 s26, s26, s94
    buffer_load_dwordx4 a[0:3], v30, s[64:67], s26 offen
    s_add_u32 s26, s26, 16384
    buffer_load_dwordx4 a[4:7], v30, s[64:67], s26 offen
    s_add_u32 s26, s26, 4294959104
    buffer_load_dwordx4 a[8:11], v30, s[64:67], s26 offen
    s_add_u32 s26, s26, 16384
    buffer_load_dwordx4 a[12:15], v30, s[64:67], s26 offen
    s_lshl_b32 s26, s21, 16
    s_add_u32 s26, s26, s94
    s_add_u32 s26, s26, 0x8000
    buffer_load_dwordx4 a[16:19], v30, s[64:67], s26 offen
    s_add_u32 s26, s26, 16384
    buffer_load_dwordx4 a[20:23], v30, s[64:67], s26 offen
    s_add_u32 s26, s26, 4294959104
    buffer_load_dwordx4 a[24:27], v30, s[64:67], s26 offen
    s_add_u32 s26, s26, 16384
    buffer_load_dwordx4 a[28:31], v30, s[64:67], s26 offen
    s_lshl_b32 s26, s22, 16
    s_add_u32 s26, s26, s94
    buffer_load_dwordx4 a[32:35], v30, s[64:67], s26 offen
    s_add_u32 s26, s26, 16384
    buffer_load_dwordx4 a[36:39], v30, s[64:67], s26 offen
    s_add_u32 s26, s26, 4294959104
    buffer_load_dwordx4 a[40:43], v30, s[64:67], s26 offen
    s_waitcnt vmcnt(12)
    s_cmp_lg_u32 s78, 0
    s_cbranch_scc1 Lok_1002
    v_cmp_ne_u32 vcc, s96, v25
    s_nop 3
    s_cmp_eq_u64 vcc, 0
    s_cbranch_scc1 Lok_1002
    s_mov_b32 s99, 0x40000
Lp_1003:
    buffer_load_dword v25, v24, s[68:71], s84 offen sc1
    s_waitcnt vmcnt(0)
    v_cmp_ne_u32 vcc, s96, v25
    s_nop 4
    s_cmp_eq_u64 vcc, 0
    s_cbranch_scc1 Lpd_1004
    s_sleep 8
    s_sub_u32 s99, s99, 1
    s_cmp_lg_u32 s99, 0
    s_cbranch_scc1 Lp_1003
Lpd_1004:
Lok_1002:
    s_barrier
    s_mov_b32 m0, s86
    s_nop 0
    buffer_load_dwordx4 v10, s[68:71], s85 offen offset:0 sc1 lds
    s_mov_b32 m0, s86
    s_nop 0
    buffer_load_dwordx4 v10, s[68:71], s85 offen offset:1024 sc1 lds
    v_mov_b32 v23, 0
    s_mov_b64 exec, 0xffff
    ds_write_b32 v22, v23
    s_mov_b64 exec, -1
    s_add_u32 s26, s26, 16384
    buffer_load_dwordx4 a[44:47], v30, s[64:67], s26 offen
    s_lshl_b32 s26, s22, 16
    s_add_u32 s26, s26, s94
    s_add_u32 s26, s26, 0x8000
    buffer_load_dwordx4 a[48:51], v30, s[64:67], s26 offen
    s_add_u32 s26, s26, 16384
    buffer_load_dwordx4 a[52:55], v30, s[64:67], s26 offen
    s_add_u32 s26, s26, 4294959104
    buffer_load_dwordx4 a[56:59], v30, s[64:67], s26 offen
    s_add_u32 s26, s26, 16384
    buffer_load_dwordx4 a[60:63], v30, s[64:67], s26 offen
    v_mov_b32 v16, 28928
    v_lshlrev_b32 v17, 2, v0
    v_add_u32 v17, v16, v17
    v_mov_b32 v18, 0
    v_mov_b32 v19, 1
    ds_write_b32 v17, v18
    s_waitcnt lgkmcnt(0)
    s_barrier
Lh8:
    s_setprio 3
    s_waitcnt vmcnt(5)
    s_mov_b64 exec, 1
    ds_add_u32 v16, v19
    s_mov_b64 exec, -1
    s_mov_b32 s99, 0x100000
Lh_1005:
    ds_read_b32 v18, v16
    s_waitcnt lgkmcnt(0)
    v_readfirstlane_b32 s80, v18
    s_sub_u32 s99, s99, 1
    s_cbranch_scc1 Lhd_1006
    s_cmp_lt_u32 s80, 4
    s_cbranch_scc1 Lh_1005
Lhd_1006:
    ds_read2_b32 v[32:33], v28 offset0:1 offset1:2
    ds_read2_b32 v[34:35], v28 offset0:3 offset1:4
    ds_read_b32 v36, v28
    v_add_u32 v28, 0x200, v28
    ds_read2_b32 v[42:43], v28 offset0:1 offset1:2
    ds_read2_b32 v[44:45], v28 offset0:3 offset1:4
    ds_read_b32 v46, v28
    v_add_u32 v28, 0x200, v28
    ds_read2_b32 v[52:53], v28 offset0:1 offset1:2
    ds_read2_b32 v[54:55], v28 offset0:3 offset1:4
    ds_read_b32 v56, v28
    v_add_u32 v28, 0x200, v28
    s_waitcnt lgkmcnt(6)
    v_alignbit_b32 v38, v32, v36, 16
    v_alignbit_b32 v39, v33, v32, 16
    v_alignbit_b32 v40, v34, v33, 16
    v_alignbit_b32 v41, v35, v34, 16
    ds_write_b128 v20, v[32:35] offset:0
    ds_write_b128 v21, v[38:41] offset:0
    ds_read2_b32 v[32:33], v28 offset0:1 offset1:2
    ds_read2_b32 v[34:35], v28 offset0:3 offset1:4
    ds_read_b32 v36, v28
    v_add_u32 v28, 0x200, v28
    s_waitcnt lgkmcnt(8)
    v_alignbit_b32 v48, v42, v46, 16
    v_alignbit_b32 v49, v43, v42, 16
    v_alignbit_b32 v50, v44, v43, 16
    v_alignbit_b32 v51, v45, v44, 16
    ds_write_b128 v20, v[42:45] offset:2048
    ds_write_b128 v21, v[48:51] offset:2048
    ds_read2_b32 v[42:43], v28 offset0:1 offset1:2
    ds_read2_b32 v[44:45], v28 offset0:3 offset1:4
    ds_read_b32 v46, v28
    v_add_u32 v28, 0x200, v28
    s_waitcnt lgkmcnt(10)
    v_alignbit_b32 v58, v52, v56, 16
    v_alignbit_b32 v59, v53, v52, 16
    v_alignbit_b32 v60, v54, v53, 16
    v_alignbit_b32 v61, v55, v54, 16
    ds_write_b128 v20, v[52:55] offset:4096
    ds_write_b128 v21, v[58:61] offset:4096
    ds_read2_b32 v[52:53], v28 offset0:1 offset1:2
    ds_read2_b32 v[54:55], v28 offset0:3 offset1:4
    ds_read_b32 v56, v28
    v_add_u32 v28, 0x200, v28
    s_waitcnt lgkmcnt(10)
    v_alignbit_b32 v38, v32, v36, 16
    v_alignbit_b32 v39, v33, v32, 16
    v_alignbit_b32 v40, v34, v33, 16
    v_alignbit_b32 v41, v35, v34, 16
    ds_write_b128 v20, v[32:35] offset:6144
    ds_write_b128 v21, v[38:41] offset:6144
    ds_read2_b32 v[32:33], v28 offset0:1 offset1:2
    ds_read2_b32 v[34:35], v28 offset0:3 offset1:4
    ds_read_b32 v36, v28
    v_add_u32 v28, 0x200, v28
    s_waitcnt lgkmcnt(10)
    v_alignbit_b32 v48, v42, v46, 16
    v_alignbit_b32 v49, v43, v42, 16
    v_alignbit_b32 v50, v44, v43, 16
    v_alignbit_b32 v51, v45, v44, 16
    ds_write_b128 v20, v[42:45] offset:8192
    ds_write_b128 v21, v[48:51] offset:8192
    ds_read2_b32 v[42:43], v28 offset0:1 offset1:2
    ds_read2_b32 v[44:45], v28 offset0:3 offset1:4
    ds_read_b32 v46, v28
    v_add_u32 v28, 0x200, v28
    s_waitcnt lgkmcnt(10)
    v_alignbit_b32 v58, v52, v56, 16
    v_alignbit_b32 v59, v53, v52, 16
    v_alignbit_b32 v60, v54, v53, 16
    v_alignbit_b32 v61, v55, v54, 16
    ds_write_b128 v20, v[52:55] offset:10240
    ds_write_b128 v21, v[58:61] offset:10240
    ds_read2_b32 v[52:53], v28 offset0:1 offset1:2
    ds_read2_b32 v[54:55], v28 offset0:3 offset1:4
    ds_read_b32 v56, v28
    v_add_u32 v28, 0x200, v28
    s_waitcnt lgkmcnt(10)
    v_alignbit_b32 v38, v32, v36, 16
    v_alignbit_b32 v39, v33, v32, 16
    v_alignbit_b32 v40, v34, v33, 16
    v_alignbit_b32 v41, v35, v34, 16
    ds_write_b128 v20, v[32:35] offset:12288
    ds_write_b128 v21, v[38:41] offset:12288
    s_waitcnt lgkmcnt(7)
    v_alignbit_b32 v48, v42, v46, 16
    v_alignbit_b32 v49, v43, v42, 16
    v_alignbit_b32 v50, v44, v43, 16
    v_alignbit_b32 v51, v45, v44, 16
    ds_write_b128 v20, v[42:45] offset:14336
    ds_write_b128 v21, v[48:51] offset:14336
    s_waitcnt lgkmcnt(4)
    v_alignbit_b32 v58, v52, v56, 16
    v_alignbit_b32 v59, v53, v52, 16
    v_alignbit_b32 v60, v54, v53, 16
    v_alignbit_b32 v61, v55, v54, 16
    s_and_b32 s80, s78, 1
    s_sub_u32 s80, s80, 1
    s_and_b32 exec_lo, s80, 0xff
    s_mov_b32 exec_hi, 0
    ds_write_b128 v20, v[52:55] offset:16384
    ds_write_b128 v21, v[58:61] offset:16384
    s_mov_b64 exec, -1
    v_add_u32 v23, s95, v10
    s_lshl_b32 s81, s78, 2
    v_add_u32 v17, s81, v16
    s_cmp_ge_u32 s77, 28
    s_cbranch_scc1 Lsk1
    ds_write_b128 v23, a[0:3] offset:0
    ds_write_b128 v23, a[4:7] offset:1024
    ds_write_b128 v23, a[8:11] offset:2048
    ds_write_b128 v23, a[12:15] offset:3072
    ds_write_b128 v23, a[16:19] offset:4096
    ds_write_b128 v23, a[20:23] offset:5120
    ds_write_b128 v23, a[24:27] offset:6144
    ds_write_b128 v23, a[28:31] offset:7168
    ds_write_b128 v23, a[32:35] offset:8192
    ds_write_b128 v23, a[36:39] offset:9216
    ds_write_b128 v23, a[40:43] offset:10240
    s_waitcnt vmcnt(4)
    ds_write_b128 v23, a[44:47] offset:11264
    s_waitcnt vmcnt(3)
    ds_write_b128 v23, a[48:51] offset:12288
    s_waitcnt vmcnt(2)
    ds_write_b128 v23, a[52:55] offset:13312
    s_waitcnt vmcnt(1)
    ds_write_b128 v23, a[56:59] offset:14336
    s_waitcnt vmcnt(0)
    ds_write_b128 v23, a[60:63] offset:15360
Lsk1:
    ds_write_b32 v17, v19 offset:32
    s_setprio 0
    s_waitcnt lgkmcnt(0)
    s_mov_b64 exec, 1
    ds_add_u32 v16, v19
    s_mov_b64 exec, -1
    s_mov_b32 s99, 0x100000
Lh_1007:
    ds_read_b32 v18, v16
    s_waitcnt lgkmcnt(0)
    v_readfirstlane_b32 s80, v18
    s_sub_u32 s99, s99, 1
    s_cbranch_scc1 Lhd_1008
    s_cmp_lt_u32 s80, 8
    s_cbranch_scc1 Lh_1007
Lhd_1008:
Lw_1009:
    ds_read_b32 v18, v17 offset:48
    s_waitcnt lgkmcnt(0)
    v_readfirstlane_b32 s80, v18
    s_sub_u32 s99, s99, 1
    s_cbranch_scc1 Lwd_1010
    s_cmp_lg_u32 s80, 0
    s_cbranch_scc1 Lwd_1010
    s_sleep 1
    s_branch Lw_1009
Lwd_1010:
    s_setprio 2
    ds_read_b128 a[0:3], v8 offset:0
    ds_read_b128 a[32:35], v9 offset:96
    ds_read_b128 a[4:7], v8 offset:2048
    ds_read_b128 a[36:39], v9 offset:352
    ds_read_b128 a[8:11], v8 offset:4096
    ds_read_b128 a[40:43], v9 offset:608
    ds_read_b128 a[12:15], v8 offset:6144
    ds_read_b128 a[44:47], v9 offset:864
    ds_read_b128 a[16:19], v8 offset:8192
    ds_read_b128 a[48:51], v9 offset:1120
    ds_read_b128 a[20:23], v8 offset:10240
    ds_read_b128 a[52:55], v9 offset:1376
    ds_read_b128 a[24:27], v8 offset:12288
    ds_read_b128 a[56:59], v9 offset:1632
    ds_read_b128 a[28:31], v8 offset:14336
    ds_read_b128 a[60:63], v9 offset:1888
    s_waitcnt lgkmcnt(14)
    v_mfma_f32_16x16x32_bf16 v[32:35], a[0:3], a[32:35], 0
    s_waitcnt lgkmcnt(12)
    v_mfma_f32_16x16x32_bf16 v[36:39], a[0:3], a[36:39], 0
    v_mfma_f32_16x16x32_bf16 v[36:39], a[4:7], a[32:35], v[36:39]
    v_mfma_f32_16x16x32_bf16 v[40:43], a[4:7], a[36:39], 0
    s_waitcnt lgkmcnt(10)
    v_mfma_f32_16x16x32_bf16 v[40:43], a[0:3], a[40:43], v[40:43]
    v_mfma_f32_16x16x32_bf16 v[44:47], a[4:7], a[40:43], 0
    v_mfma_f32_16x16x32_bf16 v[40:43], a[8:11], a[32:35], v[40:43]
    v_mfma_f32_16x16x32_bf16 v[44:47], a[8:11], a[36:39], v[44:47]
    v_mfma_f32_16x16x32_bf16 v[48:51], a[8:11], a[40:43], 0
    s_waitcnt lgkmcnt(8)
    v_mfma_f32_16x16x32_bf16 v[44:47], a[0:3], a[44:47], v[44:47]
    v_mfma_f32_16x16x32_bf16 v[48:51], a[4:7], a[44:47], v[48:51]
    v_mfma_f32_16x16x32_bf16 v[52:55], a[8:11], a[44:47], 0
    v_mfma_f32_16x16x32_bf16 v[44:47], a[12:15], a[32:35], v[44:47]
    ds_read_b128 a[64:67], v8 offset:256
    v_mfma_f32_16x16x32_bf16 v[48:51], a[12:15], a[36:39], v[48:51]
    ds_read_b128 v[128:131], v9 offset:64
    v_mfma_f32_16x16x32_bf16 v[52:55], a[12:15], a[40:43], v[52:55]
    ds_read_b128 a[68:71], v8 offset:2304
    v_mfma_f32_16x16x32_bf16 v[56:59], a[12:15], a[44:47], 0
    ds_read_b128 v[132:135], v9 offset:320
    s_waitcnt lgkmcnt(10)
    v_mfma_f32_16x16x32_bf16 v[48:51], a[0:3], a[48:51], v[48:51]
    ds_read_b128 a[72:75], v8 offset:4352
    v_mfma_f32_16x16x32_bf16 v[52:55], a[4:7], a[48:51], v[52:55]
    ds_read_b128 v[136:139], v9 offset:576
    v_mfma_f32_16x16x32_bf16 v[56:59], a[8:11], a[48:51], v[56:59]
    ds_read_b128 a[76:79], v8 offset:6400
    v_mfma_f32_16x16x32_bf16 v[60:63], a[12:15], a[48:51], 0
    ds_read_b128 v[140:143], v9 offset:832
    v_mfma_f32_16x16x32_bf16 v[48:51], a[16:19], a[32:35], v[48:51]
    ds_read_b128 a[80:83], v8 offset:8448
    v_mfma_f32_16x16x32_bf16 v[52:55], a[16:19], a[36:39], v[52:55]
    ds_read_b128 v[144:147], v9 offset:1088
    v_mfma_f32_16x16x32_bf16 v[56:59], a[16:19], a[40:43], v[56:59]
    ds_read_b128 a[84:87], v8 offset:10496
    v_mfma_f32_16x16x32_bf16 v[60:63], a[16:19], a[44:47], v[60:63]
    ds_read_b128 v[148:151], v9 offset:1344
    s_waitcnt lgkmcnt(15)
    v_mfma_f32_16x16x32_bf16 v[52:55], a[0:3], a[52:55], v[52:55]
    ds_read_b128 a[88:91], v8 offset:12544
    v_mfma_f32_16x16x32_bf16 v[56:59], a[4:7], a[52:55], v[56:59]
    ds_read_b128 v[152:155], v9 offset:1600
    v_mfma_f32_16x16x32_bf16 v[60:63], a[8:11], a[52:55], v[60:63]
    ds_read_b128 a[92:95], v8 offset:14592
    s_waitcnt lgkmcnt(15)
    v_mfma_f32_16x16x32_bf16 v[52:55], a[20:23], a[32:35], v[52:55]
    ds_read_b128 v[156:159], v9 offset:1856
    v_mfma_f32_16x16x32_bf16 v[56:59], a[20:23], a[36:39], v[56:59]
    v_mfma_f32_16x16x32_bf16 v[60:63], a[20:23], a[40:43], v[60:63]
    s_waitcnt lgkmcnt(15)
    v_mfma_f32_16x16x32_bf16 v[56:59], a[0:3], a[56:59], v[56:59]
    v_mfma_f32_16x16x32_bf16 v[60:63], a[4:7], a[56:59], v[60:63]
    v_mfma_f32_16x16x32_bf16 v[56:59], a[24:27], a[32:35], v[56:59]
    v_mfma_f32_16x16x32_bf16 v[60:63], a[24:27], a[36:39], v[60:63]
    v_mfma_f32_16x16x32_bf16 v[60:63], a[0:3], a[60:63], v[60:63]
    v_mfma_f32_16x16x32_bf16 v[60:63], a[28:31], a[32:35], v[60:63]
    s_waitcnt lgkmcnt(14)
    v_mfma_f32_16x16x32_bf16 v[32:35], a[64:67], v[128:131], v[32:35]
    s_waitcnt lgkmcnt(12)
    v_mfma_f32_16x16x32_bf16 v[36:39], a[64:67], v[132:135], v[36:39]
    v_mfma_f32_16x16x32_bf16 v[36:39], a[68:71], v[128:131], v[36:39]
    v_mfma_f32_16x16x32_bf16 v[40:43], a[68:71], v[132:135], v[40:43]
    s_waitcnt lgkmcnt(10)
    v_mfma_f32_16x16x32_bf16 v[40:43], a[64:67], v[136:139], v[40:43]
    v_mfma_f32_16x16x32_bf16 v[44:47], a[68:71], v[136:139], v[44:47]
    v_mfma_f32_16x16x32_bf16 v[40:43], a[72:75], v[128:131], v[40:43]
    v_mfma_f32_16x16x32_bf16 v[44:47], a[72:75], v[132:135], v[44:47]
    v_mfma_f32_16x16x32_bf16 v[48:51], a[72:75], v[136:139], v[48:51]
    s_waitcnt lgkmcnt(8)
    v_mfma_f32_16x16x32_bf16 v[44:47], a[64:67], v[140:143], v[44:47]
    v_mfma_f32_16x16x32_bf16 v[48:51], a[68:71], v[140:143], v[48:51]
    v_mfma_f32_16x16x32_bf16 v[52:55], a[72:75], v[140:143], v[52:55]
    v_mfma_f32_16x16x32_bf16 v[44:47], a[76:79], v[128:131], v[44:47]
    ds_read_b128 a[0:3], v8 offset:512
    v_mfma_f32_16x16x32_bf16 v[48:51], a[76:79], v[132:135], v[48:51]
    ds_read_b128 a[32:35], v9 offset:32
    v_mfma_f32_16x16x32_bf16 v[52:55], a[76:79], v[136:139], v[52:55]
    ds_read_b128 a[4:7], v8 offset:2560
    v_mfma_f32_16x16x32_bf16 v[56:59], a[76:79], v[140:143], v[56:59]
    ds_read_b128 a[36:39], v9 offset:288
    s_waitcnt lgkmcnt(10)
    v_mfma_f32_16x16x32_bf16 v[48:51], a[64:67], v[144:147], v[48:51]
    ds_read_b128 a[8:11], v8 offset:4608
    v_mfma_f32_16x16x32_bf16 v[52:55], a[68:71], v[144:147], v[52:55]
    ds_read_b128 a[40:43], v9 offset:544
    v_mfma_f32_16x16x32_bf16 v[56:59], a[72:75], v[144:147], v[56:59]
    ds_read_b128 a[12:15], v8 offset:6656
    v_mfma_f32_16x16x32_bf16 v[60:63], a[76:79], v[144:147], v[60:63]
    ds_read_b128 a[44:47], v9 offset:800
    v_mfma_f32_16x16x32_bf16 v[48:51], a[80:83], v[128:131], v[48:51]
    ds_read_b128 a[16:19], v8 offset:8704
    v_mfma_f32_16x16x32_bf16 v[52:55], a[80:83], v[132:135], v[52:55]
    ds_read_b128 a[48:51], v9 offset:1056
    v_mfma_f32_16x16x32_bf16 v[56:59], a[80:83], v[136:139], v[56:59]
    ds_read_b128 a[20:23], v8 offset:10752
    v_mfma_f32_16x16x32_bf16 v[60:63], a[80:83], v[140:143], v[60:63]
    ds_read_b128 a[52:55], v9 offset:1312
    s_waitcnt lgkmcnt(15)
    v_mfma_f32_16x16x32_bf16 v[52:55], a[64:67], v[148:151], v[52:55]
    ds_read_b128 a[24:27], v8 offset:12800
    v_mfma_f32_16x16x32_bf16 v[56:59], a[68:71], v[148:151], v[56:59]
    ds_read_b128 a[56:59], v9 offset:1568
    v_mfma_f32_16x16x32_bf16 v[60:63], a[72:75], v[148:151], v[60:63]
    ds_read_b128 a[28:31], v8 offset:14848
    s_waitcnt lgkmcnt(15)
    v_mfma_f32_16x16x32_bf16 v[52:55], a[84:87], v[128:131], v[52:55]
    ds_read_b128 a[60:63], v9 offset:1824
    v_mfma_f32_16x16x32_bf16 v[56:59], a[84:87], v[132:135], v[56:59]
    v_mfma_f32_16x16x32_bf16 v[60:63], a[84:87], v[136:139], v[60:63]
    s_waitcnt lgkmcnt(15)
    v_mfma_f32_16x16x32_bf16 v[56:59], a[64:67], v[152:155], v[56:59]
    v_mfma_f32_16x16x32_bf16 v[60:63], a[68:71], v[152:155], v[60:63]
    v_mfma_f32_16x16x32_bf16 v[56:59], a[88:91], v[128:131], v[56:59]
    v_mfma_f32_16x16x32_bf16 v[60:63], a[88:91], v[132:135], v[60:63]
    v_mfma_f32_16x16x32_bf16 v[60:63], a[64:67], v[156:159], v[60:63]
    v_mfma_f32_16x16x32_bf16 v[60:63], a[92:95], v[128:131], v[60:63]
    s_waitcnt lgkmcnt(14)
    v_mfma_f32_16x16x32_bf16 v[32:35], a[0:3], a[32:35], v[32:35]
    s_waitcnt lgkmcnt(12)
    v_mfma_f32_16x16x32_bf16 v[36:39], a[0:3], a[36:39], v[36:39]
    v_mfma_f32_16x16x32_bf16 v[36:39], a[4:7], a[32:35], v[36:39]
    v_mfma_f32_16x16x32_bf16 v[40:43], a[4:7], a[36:39], v[40:43]
    s_waitcnt lgkmcnt(10)
    v_mfma_f32_16x16x32_bf16 v[40:43], a[0:3], a[40:43], v[40:43]
    v_mfma_f32_16x16x32_bf16 v[44:47], a[4:7], a[40:43], v[44:47]
    v_mfma_f32_16x16x32_bf16 v[40:43], a[8:11], a[32:35], v[40:43]
    v_mfma_f32_16x16x32_bf16 v[44:47], a[8:11], a[36:39], v[44:47]
    v_mfma_f32_16x16x32_bf16 v[48:51], a[8:11], a[40:43], v[48:51]
    s_waitcnt lgkmcnt(8)
    v_mfma_f32_16x16x32_bf16 v[44:47], a[0:3], a[44:47], v[44:47]
    v_mfma_f32_16x16x32_bf16 v[48:51], a[4:7], a[44:47], v[48:51]
    v_mfma_f32_16x16x32_bf16 v[52:55], a[8:11], a[44:47], v[52:55]
    v_mfma_f32_16x16x32_bf16 v[44:47], a[12:15], a[32:35], v[44:47]
    ds_read_b128 a[64:67], v8 offset:768
    v_mfma_f32_16x16x32_bf16 v[48:51], a[12:15], a[36:39], v[48:51]
    ds_read_b128 v[128:131], v9 offset:0
    v_mfma_f32_16x16x32_bf16 v[52:55], a[12:15], a[40:43], v[52:55]
    ds_read_b128 a[68:71], v8 offset:2816
    v_mfma_f32_16x16x32_bf16 v[56:59], a[12:15], a[44:47], v[56:59]
    ds_read_b128 v[132:135], v9 offset:256
    s_waitcnt lgkmcnt(10)
    v_mfma_f32_16x16x32_bf16 v[48:51], a[0:3], a[48:51], v[48:51]
    ds_read_b128 a[72:75], v8 offset:4864
    v_mfma_f32_16x16x32_bf16 v[52:55], a[4:7], a[48:51], v[52:55]
    ds_read_b128 v[136:139], v9 offset:512
    v_mfma_f32_16x16x32_bf16 v[56:59], a[8:11], a[48:51], v[56:59]
    ds_read_b128 a[76:79], v8 offset:6912
    v_mfma_f32_16x16x32_bf16 v[60:63], a[12:15], a[48:51], v[60:63]
    ds_read_b128 v[140:143], v9 offset:768
    v_mfma_f32_16x16x32_bf16 v[48:51], a[16:19], a[32:35], v[48:51]
    ds_read_b128 a[80:83], v8 offset:8960
    v_mfma_f32_16x16x32_bf16 v[52:55], a[16:19], a[36:39], v[52:55]
    ds_read_b128 v[144:147], v9 offset:1024
    v_mfma_f32_16x16x32_bf16 v[56:59], a[16:19], a[40:43], v[56:59]
    ds_read_b128 a[84:87], v8 offset:11008
    v_mfma_f32_16x16x32_bf16 v[60:63], a[16:19], a[44:47], v[60:63]
    ds_read_b128 v[148:151], v9 offset:1280
    s_waitcnt lgkmcnt(15)
    v_mfma_f32_16x16x32_bf16 v[52:55], a[0:3], a[52:55], v[52:55]
    ds_read_b128 a[88:91], v8 offset:13056
    v_mfma_f32_16x16x32_bf16 v[56:59], a[4:7], a[52:55], v[56:59]
    ds_read_b128 v[152:155], v9 offset:1536
    v_mfma_f32_16x16x32_bf16 v[60:63], a[8:11], a[52:55], v[60:63]
    ds_read_b128 a[92:95], v8 offset:15104
    s_waitcnt lgkmcnt(15)
    v_mfma_f32_16x16x32_bf16 v[52:55], a[20:23], a[32:35], v[52:55]
    ds_read_b128 v[156:159], v9 offset:1792
    v_mfma_f32_16x16x32_bf16 v[56:59], a[20:23], a[36:39], v[56:59]
    v_mfma_f32_16x16x32_bf16 v[60:63], a[20:23], a[40:43], v[60:63]
    s_waitcnt lgkmcnt(15)
    v_mfma_f32_16x16x32_bf16 v[56:59], a[0:3], a[56:59], v[56:59]
    v_mfma_f32_16x16x32_bf16 v[60:63], a[4:7], a[56:59], v[60:63]
    v_mfma_f32_16x16x32_bf16 v[56:59], a[24:27], a[32:35], v[56:59]
    v_mfma_f32_16x16x32_bf16 v[60:63], a[24:27], a[36:39], v[60:63]
    v_mfma_f32_16x16x32_bf16 v[60:63], a[0:3], a[60:63], v[60:63]
    v_mfma_f32_16x16x32_bf16 v[60:63], a[28:31], a[32:35], v[60:63]
    s_waitcnt lgkmcnt(14)
    v_mfma_f32_16x16x32_bf16 v[32:35], a[64:67], v[128:131], v[32:35]
    s_waitcnt lgkmcnt(12)
    v_mfma_f32_16x16x32_bf16 v[36:39], a[64:67], v[132:135], v[36:39]
    v_mfma_f32_16x16x32_bf16 v[36:39], a[68:71], v[128:131], v[36:39]
    v_mfma_f32_16x16x32_bf16 v[40:43], a[68:71], v[132:135], v[40:43]
    s_waitcnt lgkmcnt(10)
    v_mfma_f32_16x16x32_bf16 v[40:43], a[64:67], v[136:139], v[40:43]
    v_mfma_f32_16x16x32_bf16 v[44:47], a[68:71], v[136:139], v[44:47]
    v_mfma_f32_16x16x32_bf16 v[40:43], a[72:75], v[128:131], v[40:43]
    v_mfma_f32_16x16x32_bf16 v[44:47], a[72:75], v[132:135], v[44:47]
    v_mfma_f32_16x16x32_bf16 v[48:51], a[72:75], v[136:139], v[48:51]
    s_waitcnt lgkmcnt(8)
    v_mfma_f32_16x16x32_bf16 v[44:47], a[64:67], v[140:143], v[44:47]
    v_mfma_f32_16x16x32_bf16 v[48:51], a[68:71], v[140:143], v[48:51]
    v_mfma_f32_16x16x32_bf16 v[52:55], a[72:75], v[140:143], v[52:55]
    v_mfma_f32_16x16x32_bf16 v[44:47], a[76:79], v[128:131], v[44:47]
    v_mfma_f32_16x16x32_bf16 v[48:51], a[76:79], v[132:135], v[48:51]
    v_mfma_f32_16x16x32_bf16 v[52:55], a[76:79], v[136:139], v[52:55]
    v_mfma_f32_16x16x32_bf16 v[56:59], a[76:79], v[140:143], v[56:59]
    s_waitcnt lgkmcnt(6)
    v_mfma_f32_16x16x32_bf16 v[48:51], a[64:67], v[144:147], v[48:51]
    v_mfma_f32_16x16x32_bf16 v[52:55], a[68:71], v[144:147], v[52:55]
    v_mfma_f32_16x16x32_bf16 v[56:59], a[72:75], v[144:147], v[56:59]
    v_mfma_f32_16x16x32_bf16 v[60:63], a[76:79], v[144:147], v[60:63]
    v_mfma_f32_16x16x32_bf16 v[48:51], a[80:83], v[128:131], v[48:51]
    v_mfma_f32_16x16x32_bf16 v[52:55], a[80:83], v[132:135], v[52:55]
    v_mfma_f32_16x16x32_bf16 v[56:59], a[80:83], v[136:139], v[56:59]
    v_mfma_f32_16x16x32_bf16 v[60:63], a[80:83], v[140:143], v[60:63]
    s_waitcnt lgkmcnt(4)
    v_mfma_f32_16x16x32_bf16 v[52:55], a[64:67], v[148:151], v[52:55]
    v_mfma_f32_16x16x32_bf16 v[56:59], a[68:71], v[148:151], v[56:59]
    v_mfma_f32_16x16x32_bf16 v[60:63], a[72:75], v[148:151], v[60:63]
    v_mfma_f32_16x16x32_bf16 v[52:55], a[84:87], v[128:131], v[52:55]
    v_mfma_f32_16x16x32_bf16 v[56:59], a[84:87], v[132:135], v[56:59]
    v_mfma_f32_16x16x32_bf16 v[60:63], a[84:87], v[136:139], v[60:63]
    s_waitcnt lgkmcnt(2)
    v_mfma_f32_16x16x32_bf16 v[56:59], a[64:67], v[152:155], v[56:59]
    v_mfma_f32_16x16x32_bf16 v[60:63], a[68:71], v[152:155], v[60:63]
    v_mfma_f32_16x16x32_bf16 v[56:59], a[88:91], v[128:131], v[56:59]
    v_mfma_f32_16x16x32_bf16 v[60:63], a[88:91], v[132:135], v[60:63]
    s_waitcnt lgkmcnt(0)
    v_mfma_f32_16x16x32_bf16 v[60:63], a[64:67], v[156:159], v[60:63]
    v_mfma_f32_16x16x32_bf16 v[60:63], a[92:95], v[128:131], v[60:63]
    s_and_b32 s82, s78, 1
    s_mul_i32 s81, s79, 4224
    s_lshl_b32 s83, s82, 11
    s_add_u32 s81, s81, s83
    s_add_u32 s81, s81, 0x1700000
    s_nop 1
    s_cmp_lg_u32 s82, 0
    s_cbranch_scc1 Lx_1011
    ds_write_b128 v11, v[48:51] offset:0
    ds_write_b128 v11, v[52:55] offset:1024
    ds_write_b128 v11, v[56:59] offset:2048
    ds_write_b128 v11, v[60:63] offset:3072
    s_branch Lx_1012
Lx_1011:
    ds_write_b128 v11, v[32:35] offset:0
    ds_write_b128 v11, v[36:39] offset:1024
    ds_write_b128 v11, v[40:43] offset:2048
    ds_write_b128 v11, v[44:47] offset:3072
    s_nop 1
    v_mov_b64 v[32:33], v[48:49]
    v_mov_b64 v[34:35], v[50:51]
    v_mov_b64 v[36:37], v[52:53]
    v_mov_b64 v[38:39], v[54:55]
    v_mov_b64 v[40:41], v[56:57]
    v_mov_b64 v[42:43], v[58:59]
    v_mov_b64 v[44:45], v[60:61]
    v_mov_b64 v[46:47], v[62:63]
Lx_1012:
    s_setprio 3
    s_mov_b64 exec, 1
    ds_add_u32 v16, v19
    s_mov_b64 exec, -1
    s_mov_b32 s99, 0x100000
Lh_1013:
    ds_read_b32 v18, v16
    s_waitcnt lgkmcnt(0)
    v_readfirstlane_b32 s80, v18
    s_sub_u32 s99, s99, 1
    s_cbranch_scc1 Lhd_1014
    s_cmp_lt_u32 s80, 12
    s_cbranch_scc1 Lh_1013
Lhd_1014:
    ds_read_b128 v[128:131], v12 offset:0
    ds_read_b128 v[132:135], v12 offset:1024
    ds_read_b128 v[136:139], v12 offset:2048
    ds_read_b128 v[140:143], v12 offset:3072
    s_waitcnt lgkmcnt(3)
    v_add_f32 v32, v32, v128
    v_add_f32 v33, v33, v129
    v_add_f32 v34, v34, v130
    v_add_f32 v35, v35, v131
    v_cvt_pk_bf16_f32 v48, v32, v33
    v_cvt_pk_bf16_f32 v49, v34, v35
    ds_write_b64 v15, v[48:49] offset:0
    s_waitcnt lgkmcnt(3)
    v_add_f32 v36, v36, v132
    v_add_f32 v37, v37, v133
    v_add_f32 v38, v38, v134
    v_add_f32 v39, v39, v135
    v_cvt_pk_bf16_f32 v50, v36, v37
    v_cvt_pk_bf16_f32 v51, v38, v39
    ds_write_b64 v15, v[50:51] offset:512
    s_waitcnt lgkmcnt(3)
    v_add_f32 v40, v40, v136
    v_add_f32 v41, v41, v137
    v_add_f32 v42, v42, v138
    v_add_f32 v43, v43, v139
    v_cvt_pk_bf16_f32 v52, v40, v41
    v_cvt_pk_bf16_f32 v53, v42, v43
    ds_write_b64 v15, v[52:53] offset:1024
    s_waitcnt lgkmcnt(3)
    v_add_f32 v44, v44, v140
    v_add_f32 v45, v45, v141
    v_add_f32 v46, v46, v142
    v_add_f32 v47, v47, v143
    v_cvt_pk_bf16_f32 v54, v44, v45
    v_cvt_pk_bf16_f32 v55, v46, v47
    ds_write_b64 v15, v[54:55] offset:1536
    ds_read_b128 v[56:59], v14 offset:0
    ds_read_b128 v[60:63], v14 offset:1024
    s_waitcnt lgkmcnt(1)
    buffer_store_dwordx4 v[56:59], v10, s[68:71], s81 offen offset:0 sc1
    s_waitcnt lgkmcnt(0)
    buffer_store_dwordx4 v[60:63], v10, s[68:71], s81 offen offset:1024 sc1
    s_add_u32 s80, s95, 65536
    v_add_u32 v11, s80, v10
    s_and_b32 s82, s78, 1
    s_lshl_b32 s80, s76, 1
    s_add_u32 s80, s80, s82
    s_lshl_b32 s80, s80, 10
    s_and_b32 s81, s79, 56
    s_lshl_b32 s81, s81, 4
    s_add_u32 s80, s80, s81
    s_and_b32 s81, s79, 7
    s_lshl_b32 s81, s81, 2
    s_add_u32 s80, s80, s81
    s_add_u32 s80, s80, 0xe60000
    s_cmp_ge_u32 s77, 28
    s_cbranch_scc1 Lsk2
    ds_write_b128 v11, v[64:67] offset:0
    ds_write_b128 v11, v[68:71] offset:1024
    ds_write_b128 v11, v[72:75] offset:2048
    ds_write_b128 v11, v[76:79] offset:3072
    ds_write_b128 v11, v[80:83] offset:4096
    ds_write_b128 v11, v[84:87] offset:5120
    ds_write_b128 v11, v[88:91] offset:6144
    ds_write_b128 v11, v[92:95] offset:7168
Lsk2:
    s_waitcnt vmcnt(0)
    v_mov_b32 v8, s96
    v_mov_b32 v9, 0
    s_mov_b64 exec, 1
    buffer_store_dword v8, v9, s[68:71], s80 offen sc1
    s_mov_b64 exec, -1
    s_cmp_ge_u32 s77, 28
    s_cbranch_scc1 Lsk3
    ds_write_b128 v11, v[96:99] offset:8192
    ds_write_b128 v11, v[100:103] offset:9216
    ds_write_b128 v11, v[104:107] offset:10240
    ds_write_b128 v11, v[108:111] offset:11264
    ds_write_b128 v11, v[112:115] offset:12288
    ds_write_b128 v11, v[116:119] offset:13312
    ds_write_b128 v11, v[120:123] offset:14336
    ds_write_b128 v11, v[124:127] offset:15360
    s_branch Lsk5
Lsk3:
    s_add_u32 m0, s95, 65536
    s_lshl_b32 s93, s23, 16
    s_add_u32 s93, s93, s94
    buffer_load_dwordx4 v30, s[64:67], s93 offen lds
    s_add_u32 m0, s95, 66560
    s_add_u32 s93, s93, 16384
    buffer_load_dwordx4 v30, s[64:67], s93 offen lds
    s_add_u32 m0, s95, 67584
    s_add_u32 s93, s93, 4294959104
    buffer_load_dwordx4 v30, s[64:67], s93 offen lds
    s_add_u32 m0, s95, 68608
    s_add_u32 s93, s93, 16384
    buffer_load_dwordx4 v30, s[64:67], s93 offen lds
    s_add_u32 m0, s95, 69632
    s_add_u32 s93, s93, 8192
    buffer_load_dwordx4 v30, s[64:67], s93 offen lds
    s_add_u32 m0, s95, 70656
    s_add_u32 s93, s93, 16384
    buffer_load_dwordx4 v30, s[64:67], s93 offen lds
    s_add_u32 m0, s95, 71680
    s_add_u32 s93, s93, 4294959104
    buffer_load_dwordx4 v30, s[64:67], s93 offen lds
    s_add_u32 m0, s95, 72704
    s_add_u32 s93, s93, 16384
    buffer_load_dwordx4 v30, s[64:67], s93 offen lds
    s_add_u32 m0, s95, 73728
    s_lshl_b32 s93, s24, 16
    s_add_u32 s93, s93, s94
    buffer_load_dwordx4 v30, s[64:67], s93 offen lds
    s_add_u32 m0, s95, 74752
    s_add_u32 s93, s93, 16384
    buffer_load_dwordx4 v30, s[64:67], s93 offen lds
    s_add_u32 m0, s95, 75776
    s_add_u32 s93, s93, 4294959104
    buffer_load_dwordx4 v30, s[64:67], s93 offen lds
    s_add_u32 m0, s95, 76800
    s_add_u32 s93, s93, 16384
    buffer_load_dwordx4 v30, s[64:67], s93 offen lds
    s_add_u32 m0, s95, 77824
    s_add_u32 s93, s93, 8192
    buffer_load_dwordx4 v30, s[64:67], s93 offen lds
    s_add_u32 m0, s95, 78848
    s_add_u32 s93, s93, 16384
    buffer_load_dwordx4 v30, s[64:67], s93 offen lds
    s_add_u32 m0, s95, 79872
    s_add_u32 s93, s93, 4294959104
    buffer_load_dwordx4 v30, s[64:67], s93 offen lds
    s_add_u32 m0, s95, 80896
    s_add_u32 s93, s93, 16384
    buffer_load_dwordx4 v30, s[64:67], s93 offen lds
    s_waitcnt vmcnt(0)
Lsk5:
    ds_write_b32 v17, v19 offset:16
    s_setprio 0
    v_and_b32 v5, 31, v0
    v_lshlrev_b32 v20, 3, v5
    s_lshl_b32 s82, s98, 1
    s_lshr_b32 s81, s97, 4
    s_add_u32 s82, s82, s81
    s_lshl_b32 s82, s82, 10
    s_lshr_b32 s81, s78, 1
    s_lshl_b32 s81, s81, 9
    s_add_u32 s82, s82, s81
    s_add_u32 s82, s82, 0xe60000
    s_add_u32 s50, s48, s82
    s_addc_u32 s51, s49, 0
    v_lshrrev_b32 v7, 2, v0
    v_mul_u32_u24 v8, 4224, v7
    v_and_b32 v9, 3, v0
    v_lshlrev_b32 v9, 4, v9
    v_add_u32 v8, v8, v9
    s_mul_i32 s83, s98, 270336
    s_lshr_b32 s81, s78, 1
    s_mul_i32 s81, s81, 135168
    s_add_u32 s83, s83, s81
    s_lshl_b32 s81, s97, 7
    s_add_u32 s83, s83, s81
    s_and_b32 s81, s78, 1
    s_lshl_b32 s81, s81, 6
    s_add_u32 s83, s83, s81
    s_add_u32 s83, s83, 0x1700000
    s_add_u32 s84, s83, 67584
    s_lshl_b32 s85, s97, 9
    s_and_b32 s81, s78, 1
    s_lshl_b32 s81, s81, 8
    s_add_u32 s85, s85, s81
    s_add_u32 s85, s85, 0xea0000
    s_lshl_b32 s86, s78, 12
    s_add_u32 s86, s86, 0
    v_add_u32 v21, s86, v10
    v_lshrrev_b32 v22, 5, v0
    v_lshlrev_b32 v22, 2, v22
    v_bfe_u32 v23, v0, 2, 2
    v_add_u32 v22, v22, v23
    v_lshlrev_b32 v22, 6, v22
    v_bfe_u32 v23, v0, 4, 1
    v_lshlrev_b32 v23, 5, v23
    v_add_u32 v22, v22, v23
    v_and_b32 v23, 3, v0
    v_lshlrev_b32 v23, 3, v23
    v_add_u32 v22, v22, v23
    v_add_u32 v22, s86, v22
    s_and_b32 s80, s3, 3
    s_lshl_b32 s80, s80, 3
    v_lshrrev_b32 v28, 3, v0
    v_add_u32 v26, s80, v28
    v_lshlrev_b32 v27, 10, v28
    v_and_b32 v28, 7, v0
    v_lshlrev_b32 v24, 4, v28
    v_add_u32 v27, v27, v24
    v_mul_u32_u24 v24, 0x420, v28
    v_lshlrev_b32 v25, 4, v26
    v_xor_b32 v24, v24, v25
    s_lshr_b32 s81, s3, 2
    s_lshl_b32 s80, s81, 13
    s_add_u32 s80, s80, 32768
    v_add_u32 v24, s80, v24
    v_lshlrev_b32 v25, 6, v26
    v_and_b32 v28, 3, v0
    v_lshlrev_b32 v28, 4, v28
    v_add_u32 v25, v25, v28
    v_bfe_u32 v28, v0, 2, 1
    v_lshlrev_b32 v28, 13, v28
    v_add_u32 v25, v25, v28
    s_lshl_b32 s80, s81, 12
    s_add_u32 s80, s80, 0
    v_add_u32 v25, s80, v25
    v_lshlrev_b32 v26, 2, v26
    v_add_u32 v26, s80, v26
    s_lshl_b32 s87, s97, 16
    s_lshl_b32 s81, s3, 13
    s_add_u32 s87, s87, s81
    s_lshl_b32 s81, s98, 7
    s_add_u32 s87, s87, s81
    v_and_b32 v29, 31, v0
    v_lshlrev_b32 v30, 2, v29
    v_add_u32 v30, s86, v30
    v_lshlrev_b32 v29, 6, v29
    v_lshrrev_b32 v23, 5, v0
    v_lshlrev_b32 v23, 3, v23
    v_add_u32 v29, v29, v23
    v_add_u32 v29, s86, v29
    v_bfe_u32 v5, v0, 3, 2
    v_lshlrev_b32 v5, 7, v5
    v_and_b32 v6, 7, v0
    v_lshlrev_b32 v6, 2, v6
    v_add_u32 v5, v5, v6
    v_lshrrev_b32 v6, 5, v0
    v_lshlrev_b32 v6, 16, v6
    v_add_u32 v20, v20, v6
    s_mov_b32 s99, 0x40000
Lgp:
    s_add_u32 s80, s85, 0
    buffer_load_dwordx2 v[32:33], v20, s[68:71], s80 offen sc1
    s_add_u32 s80, s85, 16384
    buffer_load_dwordx2 v[34:35], v20, s[68:71], s80 offen sc1
    s_add_u32 s80, s85, 32768
    buffer_load_dwordx2 v[36:37], v20, s[68:71], s80 offen sc1
    s_add_u32 s80, s85, 49152
    buffer_load_dwordx2 v[38:39], v20, s[68:71], s80 offen sc1
    s_waitcnt vmcnt(0)
    v_xor_b32 v33, s96, v33
    v_xor_b32 v35, s96, v35
    v_xor_b32 v37, s96, v37
    v_xor_b32 v39, s96, v39
    v_or_b32 v33, v33, v35
    v_or_b32 v37, v37, v39
    v_or_b32 v33, v33, v37
    v_cmp_ne_u32 vcc, 0, v33
    s_nop 4
    s_cmp_eq_u64 vcc, 0
    s_cbranch_scc1 Lgd
    s_sleep 8
    s_sub_u32 s99, s99, 1
    s_cbranch_scc0 Lgp
Lgd:
    s_mov_b32 s99, 0x40000
Lp_1015:
    buffer_load_dword v6, v5, s[68:71], s82 offen sc1
    s_waitcnt vmcnt(0)
    v_cmp_ne_u32 vcc, s96, v6
    s_nop 4
    s_cmp_eq_u64 vcc, 0
    s_cbranch_scc1 Lpd_1016
    s_sleep 16
    s_sub_u32 s99, s99, 1
    s_cmp_lg_u32 s99, 0
    s_cbranch_scc1 Lp_1015
Lpd_1016:
    buffer_load_dwordx4 v[12:15], v8, s[68:71], s83 offen sc1
    buffer_load_dwordx4 v[16:19], v8, s[68:71], s84 offen sc1
    v_add_f32 v32, v32, v34
    v_add_f32 v36, v36, v38
    v_add_f32 v2, v32, v36
    v_mov_b32 v3, v2
    s_nop 0
    s_nop 0
    v_permlane32_swap_b32 v2, v3
    v_add_f32 v2, v2, v3
    v_cvt_pk_bf16_f32 v2, v2, v2
    v_lshlrev_b32 v2, 16, v2
    v_mul_f32 v2, 0xbfb8aa3b, v2
    v_exp_f32 v2, v2
    s_nop 0
    v_add_f32 v2, 1.0, v2
    v_rcp_f32 v2, v2
    s_nop 0
    v_cvt_pk_bf16_f32 v2, v2, v2
    v_lshlrev_b32 v2, 16, v2
    v_sub_f32 v3, 1.0, v2
    v_cvt_pk_bf16_f32 v3, v3, v3
    v_lshlrev_b32 v3, 16, v3
    s_waitcnt vmcnt(1)
    ds_write_b128 v21, v[12:15]
    s_waitcnt vmcnt(0)
    ds_write_b128 v21, v[16:19] offset:1024
    ds_read_b64_tr_b16 v[32:33], v22 offset:0
    ds_read_b64_tr_b16 v[34:35], v22 offset:512
    ds_read_b64_tr_b16 v[36:37], v22 offset:1024
    ds_read_b64_tr_b16 v[38:39], v22 offset:1536
    s_waitcnt lgkmcnt(3)
    v_lshlrev_b32 v48, 16, v32
    v_and_b32 v49, 0xffff0000, v32
    v_mul_f32 v48, v2, v48
    v_mul_f32 v49, v2, v49
    v_cvt_pk_bf16_f32 v40, v48, v49
    v_lshlrev_b32 v50, 16, v33
    v_and_b32 v51, 0xffff0000, v33
    v_mul_f32 v50, v2, v50
    v_mul_f32 v51, v2, v51
    v_cvt_pk_bf16_f32 v41, v50, v51
    s_waitcnt lgkmcnt(2)
    v_lshlrev_b32 v52, 16, v34
    v_and_b32 v53, 0xffff0000, v34
    v_mul_f32 v52, v2, v52
    v_mul_f32 v53, v2, v53
    v_cvt_pk_bf16_f32 v42, v52, v53
    v_lshlrev_b32 v54, 16, v35
    v_and_b32 v55, 0xffff0000, v35
    v_mul_f32 v54, v2, v54
    v_mul_f32 v55, v2, v55
    v_cvt_pk_bf16_f32 v43, v54, v55
    s_waitcnt lgkmcnt(1)
    v_lshlrev_b32 v56, 16, v36
    v_and_b32 v57, 0xffff0000, v36
    v_mul_f32 v56, v2, v56
    v_mul_f32 v57, v2, v57
    v_cvt_pk_bf16_f32 v44, v56, v57
    v_lshlrev_b32 v58, 16, v37
    v_and_b32 v59, 0xffff0000, v37
    v_mul_f32 v58, v2, v58
    v_mul_f32 v59, v2, v59
    v_cvt_pk_bf16_f32 v45, v58, v59
    s_waitcnt lgkmcnt(0)
    v_lshlrev_b32 v60, 16, v38
    v_and_b32 v61, 0xffff0000, v38
    v_mul_f32 v60, v2, v60
    v_mul_f32 v61, v2, v61
    v_cvt_pk_bf16_f32 v46, v60, v61
    v_lshlrev_b32 v62, 16, v39
    v_and_b32 v63, 0xffff0000, v39
    v_mul_f32 v62, v2, v62
    v_mul_f32 v63, v2, v63
    v_cvt_pk_bf16_f32 v47, v62, v63
    ds_write_b64 v29, v[40:41] offset:2048
    ds_write_b64 v29, v[42:43] offset:2064
    ds_write_b64 v29, v[44:45] offset:2080
    ds_write_b64 v29, v[46:47] offset:2096
    ds_write_b32 v30, v3
    s_waitcnt lgkmcnt(0)
    s_cmp_lg_u32 s2, 255
    s_cbranch_scc1 Leb_1017
    s_cmp_lg_u32 s78, 0
    s_cbranch_scc1 Leb_1017
    v_lshrrev_b32 v100, 3, v0
    v_lshlrev_b32 v100, 11, v100
    v_and_b32 v101, 7, v0
    v_lshlrev_b32 v101, 7, v101
    v_add_u32 v100, v100, v101
    s_mov_b32 s80, 0xe60000
    s_mov_b32 s99, 0x40000
Lep_1018:
    buffer_load_dwordx4 v[104:107], v100, s[68:71], s80 offen sc1
    buffer_load_dwordx4 v[108:111], v100, s[68:71], s80 offen offset:16 sc1
    s_waitcnt vmcnt(0)
    v_xor_b32 v104, s96, v104
    v_xor_b32 v106, s96, v106
    v_xor_b32 v108, s96, v108
    v_xor_b32 v110, s96, v110
    v_or_b32 v104, v104, v106
    v_or_b32 v108, v108, v110
    v_or_b32 v104, v104, v108
    v_cmp_ne_u32 vcc, 0, v104
    s_nop 4
    s_cmp_eq_u64 vcc, 0
    s_cbranch_scc1 Led_1019
    s_sleep 8
    s_sub_u32 s99, s99, 1
    s_cbranch_scc0 Lep_1018
Led_1019:
    s_mov_b32 s80, 0xe10000
    v_mov_b32 v100, s96
    v_mov_b32 v101, 0
    s_mov_b64 exec, 1
    buffer_store_dword v100, v101, s[68:71], s80 offen sc1
    s_mov_b64 exec, -1
Leb_1017:
    s_barrier
    ds_read_b128 v[64:67], v24 offset:0
    ds_read_b128 v[72:75], v24 offset:16384
    ds_read_b128 v[80:83], v24 offset:32768
    ds_read_b128 v[88:91], v24 offset:49152
    ds_read_b32 v3, v26
    ds_read_b128 v[68:71], v24 offset:512
    ds_read_b128 v[76:79], v24 offset:16896
    ds_read_b128 v[84:87], v24 offset:33280
    ds_read_b128 v[92:95], v24 offset:49664
    ds_read_b128 v[44:47], v25 offset:2048
    s_waitcnt lgkmcnt(8)
    v_pk_add_f32 v[64:65], v[64:65], v[72:73]
    s_waitcnt lgkmcnt(6)
    v_pk_add_f32 v[80:81], v[80:81], v[88:89]
    v_pk_add_f32 v[66:67], v[66:67], v[74:75]
    v_pk_add_f32 v[82:83], v[82:83], v[90:91]
    s_waitcnt lgkmcnt(3)
    v_pk_add_f32 v[68:69], v[68:69], v[76:77]
    s_waitcnt lgkmcnt(1)
    v_pk_add_f32 v[84:85], v[84:85], v[92:93]
    v_pk_add_f32 v[70:71], v[70:71], v[78:79]
    v_pk_add_f32 v[86:87], v[86:87], v[94:95]
    v_pk_add_f32 v[64:65], v[64:65], v[80:81]
    v_pk_add_f32 v[66:67], v[66:67], v[82:83]
    v_pk_add_f32 v[68:69], v[68:69], v[84:85]
    v_pk_add_f32 v[70:71], v[70:71], v[86:87]
    s_waitcnt lgkmcnt(0)
    v_lshlrev_b32 v80, 16, v44
    v_and_b32 v81, 0xffff0000, v44
    v_lshlrev_b32 v82, 16, v45
    v_and_b32 v83, 0xffff0000, v45
    v_lshlrev_b32 v84, 16, v46
    v_and_b32 v85, 0xffff0000, v46
    v_lshlrev_b32 v86, 16, v47
    v_and_b32 v87, 0xffff0000, v47
    v_fmac_f32 v80, v3, v64
    v_fmac_f32 v81, v3, v65
    v_fmac_f32 v82, v3, v66
    v_fmac_f32 v83, v3, v67
    v_fmac_f32 v84, v3, v68
    v_fmac_f32 v85, v3, v69
    v_fmac_f32 v86, v3, v70
    v_fmac_f32 v87, v3, v71
    v_cvt_pk_bf16_f32 v44, v80, v81
    v_cvt_pk_bf16_f32 v45, v82, v83
    v_cvt_pk_bf16_f32 v46, v84, v85
    v_cvt_pk_bf16_f32 v47, v86, v87
    buffer_store_dwordx4 v[44:47], v27, s[72:75], s87 offen sc1
    s_endpgm
Lcompute:
    v_and_b32 v0, 63, v0
    s_and_b32 s76, s2, 7
    s_lshr_b32 s77, s2, 3
    s_lshr_b32 s80, s76, 1
    s_mul_i32 s80, s80, 28
    s_add_u32 s80, s80, s77
    s_lshr_b32 s89, s80, 3
    s_and_b32 s80, s80, 7
    s_and_b32 s81, s76, 1
    s_lshl_b32 s81, s81, 3
    s_add_u32 s88, s80, s81
    s_mul_i32 s80, s77, 37
    s_lshr_b32 s80, s80, 8
    s_mul_i32 s81, s80, 7
    s_sub_u32 s81, s77, s81
    s_cmp_ge_u32 s81, 3
    s_addc_u32 s98, s81, 0
    s_cmp_ge_u32 s77, 28
    s_cselect_b32 s98, 3, s98
    s_cselect_b32 s80, s81, s80
    s_lshl_b32 s97, s76, 2
    s_add_u32 s97, s97, s80
    s_and_b32 s78, s3, 3
    s_lshl_b32 s80, s76, 6
    s_lshl_b32 s81, s77, 1
    s_add_u32 s80, s80, s81
    s_lshr_b32 s81, s78, 1
    s_add_u32 s79, s80, s81
    s_lshl_b32 s80, s79, 8
    s_and_b32 s81, s78, 1
    s_lshl_b32 s81, s81, 7
    s_add_u32 s80, s80, s81
    v_lshlrev_b32 v32, 1, v0
    v_add_u32 v32, s80, v32
    s_lshl_b32 s80, s79, 1
    v_mov_b32 v63, s80
    s_lshr_b32 s80, s78, 1
    s_mul_i32 s80, s80, 28672
    s_and_b32 s81, s78, 1
    s_mul_i32 s81, s81, 7168
    s_add_u32 s80, s80, s81
    s_add_u32 s80, s80, 98304
    v_mul_u32_u24 v62, 112, v0
    v_add_u32 v62, s80, v62
    s_waitcnt lgkmcnt(0)
    global_load_ushort v39, v63, s[30:31]
    global_load_ushort v33, v32, s[18:19]
    global_load_ushort v34, v32, s[20:21]
    global_load_ushort v35, v32, s[22:23]
    global_load_ushort v36, v32, s[24:25]
    global_load_ushort v37, v32, s[26:27]
    global_load_ushort v38, v32, s[28:29]
    global_load_ushort v59, v63, s[32:33]
    s_add_u32 s50, s48, 0xe10000
    s_addc_u32 s51, s49, 0
    s_load_dword s96, s[50:51], 0
    s_mov_b32 s52, s16
    s_and_b32 s53, s17, 0xffff
    s_mov_b32 s54, 0x200000
    s_mov_b32 s55, 0x20000
    s_mov_b32 s64, s40
    s_and_b32 s65, s41, 0xffff
    s_mov_b32 s66, 0x1c0000
    s_mov_b32 s67, 0x20000
    s_mov_b32 s68, s48
    s_and_b32 s69, s49, 0xffff
    s_mov_b32 s70, 0x10000000
    s_mov_b32 s71, 0x20000
    s_mov_b32 s72, s44
    s_and_b32 s73, s45, 0xffff
    s_mov_b32 s74, 0x200000
    s_mov_b32 s75, 0x20000
    s_lshr_b32 s80, s78, 1
    s_mul_i32 s80, s80, 28672
    s_add_u32 s80, s80, 98304
    v_lshrrev_b32 v52, 2, v0
    v_mul_u32_u24 v52, 112, v52
    v_and_b32 v53, 3, v0
    v_lshlrev_b32 v53, 3, v53
    v_add_u32 v52, v52, v53
    v_add_u32 v52, s80, v52
    s_and_b32 s81, s78, 1
    s_lshl_b32 s81, s81, 5
    s_add_u32 s81, s81, 48
    v_add_u32 v53, s81, v52
    s_and_b32 s81, s78, 1
    s_lshl_b32 s81, s81, 4
    v_and_b32 v152, 15, v0
    v_add_u32 v152, s81, v152
    v_lshrrev_b32 v153, 4, v0
    v_lshlrev_b32 v154, 3, v152
    v_lshlrev_b32 v155, 2, v153
    v_add_u32 v154, v154, v155
    v_lshlrev_b32 v155, 2, v152
    v_add_u32 v155, 0x100, v155
    v_lshlrev_b32 v156, 1, v152
    v_add_u32 v156, 0x180, v156
    v_cmp_eq_u32 vcc, 2, v153
    s_nop 1
    v_cndmask_b32 v154, v154, v155, vcc
    v_cmp_eq_u32 vcc, 3, v153
    s_nop 1
    v_cndmask_b32 v154, v154, v156, vcc
    v_mov_b32 v155, 2
    v_mov_b32 v156, 64
    v_cndmask_b32 v155, v155, v156, vcc
    v_add_u32 v155, v154, v155
    s_lshr_b32 s80, s78, 1
    s_mul_i32 s80, s80, 1536
    s_add_u32 s80, s80, 160768
    v_lshlrev_b32 v154, 1, v154
    v_add_u32 v54, s80, v154
    v_lshlrev_b32 v155, 1, v155
    v_add_u32 v55, s80, v155
    v_min_u32 v156, 1, v153
    v_lshlrev_b32 v156, 7, v156
    v_add_u32 v156, v156, v152
    v_add_u32 v156, 0x200, v156
    v_lshlrev_b32 v156, 1, v156
    v_add_u32 v56, s80, v156
    v_and_b32 v5, 15, v0
    v_lshrrev_b32 v6, 4, v0
    v_bfe_u32 v7, v0, 1, 3
    v_xor_b32 v7, v6, v7
    v_lshlrev_b32 v7, 4, v7
    v_lshlrev_b32 v5, 7, v5
    v_add_u32 v5, v5, v7
    s_and_b32 s80, s78, 1
    s_lshl_b32 s80, s80, 13
    v_add_u32 v8, s80, v5
    v_xor_b32 v9, 64, v8
    v_lshlrev_b32 v5, 3, v6
    v_bfe_u32 v7, v0, 2, 2
    v_add_u32 v5, v5, v7
    v_lshlrev_b32 v5, 8, v5
    v_lshlrev_b32 v7, 1, v7
    v_and_b32 v6, 1, v6
    v_or_b32 v6, v6, v7
    s_lshr_b32 s80, s78, 1
    s_lshl_b32 s80, s80, 2
    v_xor_b32 v6, s80, v6
    v_lshlrev_b32 v6, 5, v6
    v_add_u32 v5, v5, v6
    v_and_b32 v6, 3, v0
    v_lshlrev_b32 v6, 3, v6
    v_add_u32 v5, v5, v6
    v_add_u32 v10, 0x4000, v5
    v_xor_b32 v11, 32, v10
    v_xor_b32 v12, 64, v10
    v_xor_b32 v13, 96, v10
    v_add_u32 v14, 0xc000, v8
    v_add_u32 v20, 0x18000, v8
    v_add_u32 v15, 0xc000, v9
    v_add_u32 v21, 0x18000, v9
    v_add_u32 v16, 0xc000, v10
    v_add_u32 v22, 0x18000, v10
    v_add_u32 v17, 0xc000, v11
    v_add_u32 v23, 0x18000, v11
    v_add_u32 v18, 0xc000, v12
    v_add_u32 v24, 0x18000, v12
    v_add_u32 v19, 0xc000, v13
    v_add_u32 v25, 0x18000, v13
    v_lshlrev_b32 v26, 4, v0
    s_lshr_b32 s80, s78, 1
    s_lshl_b32 s80, s80, 10
    v_add_u32 v26, s80, v26
    v_xor_b32 v27, 0x400, v26
    s_lshl_b32 s94, s98, 2
    s_add_u32 s94, s94, s78
    s_lshl_b32 s94, s94, 15
    s_add_u32 s94, s94, 0x1a00000
    s_mov_b32 s18, 0
    s_mov_b32 s19, 1
    s_mov_b32 s20, 2
    s_mov_b32 s21, 3
    s_mov_b32 s22, 4
    s_mov_b32 s23, 5
    s_mov_b32 s24, 6
    s_lshl_b32 s95, s78, 14
    s_add_u32 s95, s95, 32768
    s_lshl_b32 s25, s78, 13
    s_lshl_b32 s80, s88, 1
    s_and_b32 s81, s78, 1
    s_add_u32 s80, s80, s81
    s_lshl_b32 s80, s80, 9
    s_lshl_b32 s81, s89, 1
    s_lshr_b32 s82, s78, 1
    s_add_u32 s81, s81, s82
    s_mul_i32 s82, s81, 37
    s_lshr_b32 s82, s82, 8
    s_mul_i32 s82, s82, 100
    s_lshl_b32 s81, s81, 2
    s_add_u32 s80, s80, s81
    s_add_u32 s80, s80, s82
    s_add_u32 s87, s80, 0xe40000
    s_add_u32 s86, s87, 0x8000
    s_lshl_b32 s80, s78, 2
    s_add_u32 s80, s80, 28944
    v_mov_b32 v30, s80
    v_lshrrev_b32 v7, 5, v0
    v_lshlrev_b32 v7, 2, v7
    v_bfe_u32 v2, v0, 2, 2
    v_add_u32 v7, v7, v2
    v_lshlrev_b32 v7, 7, v7
    v_bfe_u32 v2, v0, 3, 1
    s_lshr_b32 s80, s78, 1
    v_xor_b32 v2, s80, v2
    v_lshlrev_b32 v2, 6, v2
    v_add_u32 v7, v7, v2
    v_bfe_u32 v2, v0, 4, 1
    v_lshlrev_b32 v2, 5, v2
    v_add_u32 v7, v7, v2
    v_and_b32 v2, 3, v0
    v_lshlrev_b32 v2, 3, v2
    v_add_u32 v7, v7, v2
    v_add_u32 v5, s95, v7
    v_xor_b32 v6, 64, v5
    v_add_u32 v28, 0x10000, v5
    v_add_u32 v29, 0x10000, v6
    v_lshlrev_b32 v1, 4, v0
    s_and_b32 s80, s78, 1
    s_mul_i32 s81, s80, 114688
    s_xor_b32 s80, s80, 1
    s_mul_i32 s80, s80, 114688
    v_add_u32 v7, s80, v1
    v_add_u32 v1, s81, v1
    s_mul_i32 s91, s97, 229376
    s_mul_i32 s80, s78, 28672
    s_add_u32 s91, s91, s80
    s_add_u32 s91, s91, 0x400000
    s_lshl_b32 s80, s97, 9
    s_lshl_b32 s81, s78, 7
    s_add_u32 s80, s80, s81
    s_add_u32 s80, s80, 0xe40000
    s_add_u32 s50, s48, s80
    s_addc_u32 s51, s49, 0
    s_waitcnt lgkmcnt(0)
    s_mul_i32 s96, s96, 0x9E3779B1
    s_add_u32 s96, s96, 0x7F4A7C15
    s_waitcnt vmcnt(7)
    v_lshlrev_b32 v39, 16, v39
    v_mul_f32 v39, 0x3fb8aa3b, v39
    v_exp_f32 v39, v39
    s_waitcnt vmcnt(6)
    v_lshlrev_b32 v33, 16, v33
    s_waitcnt vmcnt(5)
    v_lshlrev_b32 v34, 16, v34
    v_cvt_pk_bf16_f32 v39, v39, v39
    v_lshlrev_b32 v39, 16, v39
    v_mul_f32 v33, v39, v33
    v_mul_f32 v34, v39, v34
    v_mul_f32 v33, 0x3fb8aa3b, v33
    v_mul_f32 v34, 0x3e22f983, v34
    s_waitcnt vmcnt(4)
    v_lshlrev_b32 v35, 16, v35
    s_waitcnt vmcnt(3)
    v_lshlrev_b32 v36, 16, v36
    s_waitcnt vmcnt(2)
    v_lshlrev_b32 v37, 16, v37
    s_waitcnt vmcnt(1)
    v_lshlrev_b32 v38, 16, v38
    v_mul_f32 v46, 0x41000000, v33
    v_mul_f32 v47, 0x41000000, v34
    v_exp_f32 v46, v46
    v_fract_f32 v47, v47
    v_cos_f32 v148, v47
    v_sin_f32 v149, v47
    v_mul_f32 v148, v46, v148
    v_mul_f32 v149, v46, v149
    v_mul_f32 v48, 0x41800000, v33
    v_mul_f32 v49, 0x41800000, v34
    v_exp_f32 v48, v48
    v_fract_f32 v49, v49
    v_cos_f32 v150, v49
    v_sin_f32 v151, v49
    v_mul_f32 v150, v48, v150
    v_mul_f32 v151, v48, v151
    v_exp_f32 v50, v33
    v_fract_f32 v51, v34
    v_cos_f32 v40, v51
    v_sin_f32 v41, v51
    v_mul_f32 v40, v50, v40
    v_mul_f32 v41, v50, v41
    v_mul_f32 v46, 0x40000000, v33
    v_mul_f32 v47, 0x40000000, v34
    v_exp_f32 v46, v46
    v_fract_f32 v47, v47
    v_cos_f32 v42, v47
    v_sin_f32 v43, v47
    v_mul_f32 v42, v46, v42
    v_mul_f32 v43, v46, v43
    v_mul_f32 v48, 0x43800000, v33
    v_mul_f32 v49, 0x43800000, v34
    v_exp_f32 v48, v48
    v_fract_f32 v49, v49
    v_cos_f32 v44, v49
    v_sin_f32 v45, v49
    v_mul_f32 v44, v48, v44
    v_mul_f32 v45, v48, v45
    v_mul_f32 v35, v39, v35
    v_mul_f32 v36, v39, v36
    v_mul_f32 v88, v37, v35
    v_mul_f32 v89, v37, v36
    v_fma_f32 v88, -v38, v36, v88
    v_fma_f32 v89, v38, v35, v89
    v_cvt_pk_bf16_f32 v132, 1.0, v148
    v_cvt_pk_bf16_f32 v136, 0, v149
    v_pk_mul_f32 v[158:159], v[148:149], v[150:151] op_sel:[0,0] op_sel_hi:[0,1]
    v_pk_mul_f32 v[90:91], v[88:89], v[40:41] op_sel:[0,0] op_sel_hi:[0,1]
    v_pk_mul_f32 v[92:93], v[88:89], v[42:43] op_sel:[0,0] op_sel_hi:[0,1]
    v_pk_fma_f32 v[158:159], v[148:149], v[150:151], v[158:159] op_sel:[1,1,0] op_sel_hi:[1,0,1] neg_lo:[1,0,0]
    v_pk_mul_f32 v[152:153], v[150:151], v[150:151] op_sel:[0,0] op_sel_hi:[0,1]
    v_pk_mul_f32 v[154:155], v[158:159], v[150:151] op_sel:[0,0] op_sel_hi:[0,1]
    v_pk_fma_f32 v[90:91], v[88:89], v[40:41], v[90:91] op_sel:[1,1,0] op_sel_hi:[1,0,1] neg_lo:[1,0,0]
    v_pk_fma_f32 v[92:93], v[88:89], v[42:43], v[92:93] op_sel:[1,1,0] op_sel_hi:[1,0,1] neg_lo:[1,0,0]
    v_cvt_pk_bf16_f32 v133, v150, v158
    v_cvt_pk_bf16_f32 v137, v151, v159
    v_pk_fma_f32 v[152:153], v[150:151], v[150:151], v[152:153] op_sel:[1,1,0] op_sel_hi:[1,0,1] neg_lo:[1,0,0]
    v_pk_mul_f32 v[104:105], v[88:89], v[44:45] op_sel:[0,0] op_sel_hi:[0,1]
    v_pk_mul_f32 v[94:95], v[90:91], v[42:43] op_sel:[0,0] op_sel_hi:[0,1]
    v_pk_fma_f32 v[154:155], v[158:159], v[150:151], v[154:155] op_sel:[1,1,0] op_sel_hi:[1,0,1] neg_lo:[1,0,0]
    v_pk_mul_f32 v[156:157], v[152:153], v[150:151] op_sel:[0,0] op_sel_hi:[0,1]
    v_pk_mul_f32 v[158:159], v[154:155], v[150:151] op_sel:[0,0] op_sel_hi:[0,1]
    v_pk_fma_f32 v[104:105], v[88:89], v[44:45], v[104:105] op_sel:[1,1,0] op_sel_hi:[1,0,1] neg_lo:[1,0,0]
    v_pk_fma_f32 v[94:95], v[90:91], v[42:43], v[94:95] op_sel:[1,1,0] op_sel_hi:[1,0,1] neg_lo:[1,0,0]
    v_cvt_pk_bf16_f32 v134, v152, v154
    v_cvt_pk_bf16_f32 v138, v153, v155
    v_pk_fma_f32 v[156:157], v[152:153], v[150:151], v[156:157] op_sel:[1,1,0] op_sel_hi:[1,0,1] neg_lo:[1,0,0]
    v_cvt_pk_bf16_f32 v64, v88, v90
    v_cvt_pk_bf16_f32 v76, -v89, -v91
    v_pk_fma_f32 v[158:159], v[154:155], v[150:151], v[158:159] op_sel:[1,1,0] op_sel_hi:[1,0,1] neg_lo:[1,0,0]
    v_pk_mul_f32 v[152:153], v[156:157], v[150:151] op_sel:[0,0] op_sel_hi:[0,1]
    v_pk_mul_f32 v[154:155], v[158:159], v[150:151] op_sel:[0,0] op_sel_hi:[0,1]
    v_pk_mul_f32 v[96:97], v[92:93], v[42:43] op_sel:[0,0] op_sel_hi:[0,1]
    v_pk_mul_f32 v[112:113], v[104:105], v[44:45] op_sel:[0,0] op_sel_hi:[0,1]
    v_cvt_pk_bf16_f32 v135, v156, v158
    v_cvt_pk_bf16_f32 v139, v157, v159
    v_pk_fma_f32 v[152:153], v[156:157], v[150:151], v[152:153] op_sel:[1,1,0] op_sel_hi:[1,0,1] neg_lo:[1,0,0]
    v_pk_fma_f32 v[96:97], v[92:93], v[42:43], v[96:97] op_sel:[1,1,0] op_sel_hi:[1,0,1] neg_lo:[1,0,0]
    v_pk_fma_f32 v[112:113], v[104:105], v[44:45], v[112:113] op_sel:[1,1,0] op_sel_hi:[1,0,1] neg_lo:[1,0,0]
    v_pk_fma_f32 v[154:155], v[158:159], v[150:151], v[154:155] op_sel:[1,1,0] op_sel_hi:[1,0,1] neg_lo:[1,0,0]
    ds_write_b128 v62, v[132:135] offset:48
    ds_write_b128 v62, v[136:139] offset:14384
    v_cvt_pk_bf16_f32 v65, v92, v94
    v_cvt_pk_bf16_f32 v77, -v93, -v95
    v_pk_mul_f32 v[156:157], v[152:153], v[150:151] op_sel:[0,0] op_sel_hi:[0,1]
    v_pk_mul_f32 v[158:159], v[154:155], v[150:151] op_sel:[0,0] op_sel_hi:[0,1]
    v_cvt_pk_bf16_f32 v140, v152, v154
    v_pk_mul_f32 v[98:99], v[94:95], v[42:43] op_sel:[0,0] op_sel_hi:[0,1]
    v_pk_mul_f32 v[106:107], v[92:93], v[44:45] op_sel:[0,0] op_sel_hi:[0,1]
    v_cvt_pk_bf16_f32 v144, v153, v155
    v_pk_fma_f32 v[156:157], v[152:153], v[150:151], v[156:157] op_sel:[1,1,0] op_sel_hi:[1,0,1] neg_lo:[1,0,0]
    v_pk_fma_f32 v[158:159], v[154:155], v[150:151], v[158:159] op_sel:[1,1,0] op_sel_hi:[1,0,1] neg_lo:[1,0,0]
    v_pk_fma_f32 v[98:99], v[94:95], v[42:43], v[98:99] op_sel:[1,1,0] op_sel_hi:[1,0,1] neg_lo:[1,0,0]
    v_pk_fma_f32 v[106:107], v[92:93], v[44:45], v[106:107] op_sel:[1,1,0] op_sel_hi:[1,0,1] neg_lo:[1,0,0]
    v_pk_mul_f32 v[152:153], v[156:157], v[150:151] op_sel:[0,0] op_sel_hi:[0,1]
    v_pk_mul_f32 v[154:155], v[158:159], v[150:151] op_sel:[0,0] op_sel_hi:[0,1]
    v_cvt_pk_bf16_f32 v141, v156, v158
    v_pk_mul_f32 v[100:101], v[96:97], v[42:43] op_sel:[0,0] op_sel_hi:[0,1]
    v_pk_mul_f32 v[116:117], v[112:113], v[44:45] op_sel:[0,0] op_sel_hi:[0,1]
    v_cvt_pk_bf16_f32 v145, v157, v159
    v_pk_fma_f32 v[152:153], v[156:157], v[150:151], v[152:153] op_sel:[1,1,0] op_sel_hi:[1,0,1] neg_lo:[1,0,0]
    v_pk_fma_f32 v[154:155], v[158:159], v[150:151], v[154:155] op_sel:[1,1,0] op_sel_hi:[1,0,1] neg_lo:[1,0,0]
    v_pk_fma_f32 v[100:101], v[96:97], v[42:43], v[100:101] op_sel:[1,1,0] op_sel_hi:[1,0,1] neg_lo:[1,0,0]
    v_pk_fma_f32 v[116:117], v[112:113], v[44:45], v[116:117] op_sel:[1,1,0] op_sel_hi:[1,0,1] neg_lo:[1,0,0]
    v_pk_mul_f32 v[156:157], v[152:153], v[150:151] op_sel:[0,0] op_sel_hi:[0,1]
    v_pk_mul_f32 v[158:159], v[154:155], v[150:151] op_sel:[0,0] op_sel_hi:[0,1]
    v_cvt_pk_bf16_f32 v142, v152, v154
    v_cvt_pk_bf16_f32 v66, v96, v98
    v_cvt_pk_bf16_f32 v78, -v97, -v99
    v_cvt_pk_bf16_f32 v146, v153, v155
    v_pk_fma_f32 v[156:157], v[152:153], v[150:151], v[156:157] op_sel:[1,1,0] op_sel_hi:[1,0,1] neg_lo:[1,0,0]
    v_pk_fma_f32 v[158:159], v[154:155], v[150:151], v[158:159] op_sel:[1,1,0] op_sel_hi:[1,0,1] neg_lo:[1,0,0]
    v_cvt_pk_bf16_f32 v68, v104, v106
    v_cvt_pk_bf16_f32 v80, -v105, -v107
    v_pk_mul_f32 v[152:153], v[156:157], v[150:151] op_sel:[0,0] op_sel_hi:[0,1]
    v_pk_mul_f32 v[154:155], v[158:159], v[150:151] op_sel:[0,0] op_sel_hi:[0,1]
    v_cvt_pk_bf16_f32 v143, v156, v158
    v_pk_mul_f32 v[102:103], v[98:99], v[42:43] op_sel:[0,0] op_sel_hi:[0,1]
    v_pk_mul_f32 v[108:109], v[96:97], v[44:45] op_sel:[0,0] op_sel_hi:[0,1]
    v_cvt_pk_bf16_f32 v147, v157, v159
    v_pk_fma_f32 v[152:153], v[156:157], v[150:151], v[152:153] op_sel:[1,1,0] op_sel_hi:[1,0,1] neg_lo:[1,0,0]
    v_pk_fma_f32 v[154:155], v[158:159], v[150:151], v[154:155] op_sel:[1,1,0] op_sel_hi:[1,0,1] neg_lo:[1,0,0]
    v_pk_fma_f32 v[102:103], v[98:99], v[42:43], v[102:103] op_sel:[1,1,0] op_sel_hi:[1,0,1] neg_lo:[1,0,0]
    v_pk_fma_f32 v[108:109], v[96:97], v[44:45], v[108:109] op_sel:[1,1,0] op_sel_hi:[1,0,1] neg_lo:[1,0,0]
    ds_write_b128 v62, v[140:143] offset:64
    ds_write_b128 v62, v[144:147] offset:14400
    v_pk_mul_f32 v[156:157], v[152:153], v[150:151] op_sel:[0,0] op_sel_hi:[0,1]
    v_pk_mul_f32 v[120:121], v[116:117], v[44:45] op_sel:[0,0] op_sel_hi:[0,1]
    v_pk_mul_f32 v[110:111], v[100:101], v[44:45] op_sel:[0,0] op_sel_hi:[0,1]
    v_pk_mul_f32 v[158:159], v[154:155], v[150:151] op_sel:[0,0] op_sel_hi:[0,1]
    v_cvt_pk_bf16_f32 v132, v152, v154
    v_cvt_pk_bf16_f32 v136, v153, v155
    v_pk_fma_f32 v[120:121], v[116:117], v[44:45], v[120:121] op_sel:[1,1,0] op_sel_hi:[1,0,1] neg_lo:[1,0,0]
    v_pk_fma_f32 v[110:111], v[100:101], v[44:45], v[110:111] op_sel:[1,1,0] op_sel_hi:[1,0,1] neg_lo:[1,0,0]
    v_pk_fma_f32 v[156:157], v[152:153], v[150:151], v[156:157] op_sel:[1,1,0] op_sel_hi:[1,0,1] neg_lo:[1,0,0]
    v_pk_fma_f32 v[158:159], v[154:155], v[150:151], v[158:159] op_sel:[1,1,0] op_sel_hi:[1,0,1] neg_lo:[1,0,0]
    v_pk_mul_f32 v[152:153], v[156:157], v[150:151] op_sel:[0,0] op_sel_hi:[0,1]
    v_cvt_pk_bf16_f32 v67, v100, v102
    v_cvt_pk_bf16_f32 v79, -v101, -v103
    v_pk_mul_f32 v[154:155], v[158:159], v[150:151] op_sel:[0,0] op_sel_hi:[0,1]
    v_cvt_pk_bf16_f32 v133, v156, v158
    v_cvt_pk_bf16_f32 v137, v157, v159
    ds_write_b128 v62, v[64:67]
    ds_write_b128 v62, v[76:79] offset:14336
    v_pk_fma_f32 v[152:153], v[156:157], v[150:151], v[152:153] op_sel:[1,1,0] op_sel_hi:[1,0,1] neg_lo:[1,0,0]
    v_pk_fma_f32 v[154:155], v[158:159], v[150:151], v[154:155] op_sel:[1,1,0] op_sel_hi:[1,0,1] neg_lo:[1,0,0]
    v_pk_mul_f32 v[156:157], v[152:153], v[150:151] op_sel:[0,0] op_sel_hi:[0,1]
    v_pk_mul_f32 v[114:115], v[108:109], v[44:45] op_sel:[0,0] op_sel_hi:[0,1]
    v_pk_mul_f32 v[122:123], v[120:121], v[44:45] op_sel:[0,0] op_sel_hi:[0,1]
    v_pk_mul_f32 v[158:159], v[154:155], v[150:151] op_sel:[0,0] op_sel_hi:[0,1]
    v_cvt_pk_bf16_f32 v134, v152, v154
    v_cvt_pk_bf16_f32 v138, v153, v155
    v_pk_fma_f32 v[114:115], v[108:109], v[44:45], v[114:115] op_sel:[1,1,0] op_sel_hi:[1,0,1] neg_lo:[1,0,0]
    v_pk_fma_f32 v[122:123], v[120:121], v[44:45], v[122:123] op_sel:[1,1,0] op_sel_hi:[1,0,1] neg_lo:[1,0,0]
    v_pk_fma_f32 v[156:157], v[152:153], v[150:151], v[156:157] op_sel:[1,1,0] op_sel_hi:[1,0,1] neg_lo:[1,0,0]
    v_pk_fma_f32 v[158:159], v[154:155], v[150:151], v[158:159] op_sel:[1,1,0] op_sel_hi:[1,0,1] neg_lo:[1,0,0]
    v_pk_mul_f32 v[152:153], v[156:157], v[150:151] op_sel:[0,0] op_sel_hi:[0,1]
    v_cvt_pk_bf16_f32 v69, v108, v110
    v_cvt_pk_bf16_f32 v81, -v109, -v111
    v_pk_mul_f32 v[154:155], v[158:159], v[150:151] op_sel:[0,0] op_sel_hi:[0,1]
    v_cvt_pk_bf16_f32 v135, v156, v158
    v_cvt_pk_bf16_f32 v139, v157, v159
    v_pk_mul_f32 v[118:119], v[114:115], v[44:45] op_sel:[0,0] op_sel_hi:[0,1]
    v_pk_mul_f32 v[124:125], v[122:123], v[44:45] op_sel:[0,0] op_sel_hi:[0,1]
    v_pk_fma_f32 v[152:153], v[156:157], v[150:151], v[152:153] op_sel:[1,1,0] op_sel_hi:[1,0,1] neg_lo:[1,0,0]
    v_pk_fma_f32 v[154:155], v[158:159], v[150:151], v[154:155] op_sel:[1,1,0] op_sel_hi:[1,0,1] neg_lo:[1,0,0]
    ds_write_b128 v62, v[132:135] offset:80
    v_pk_fma_f32 v[118:119], v[114:115], v[44:45], v[118:119] op_sel:[1,1,0] op_sel_hi:[1,0,1] neg_lo:[1,0,0]
    v_pk_fma_f32 v[124:125], v[122:123], v[44:45], v[124:125] op_sel:[1,1,0] op_sel_hi:[1,0,1] neg_lo:[1,0,0]
    ds_write_b128 v62, v[136:139] offset:14416
    v_pk_mul_f32 v[156:157], v[152:153], v[150:151] op_sel:[0,0] op_sel_hi:[0,1]
    v_pk_mul_f32 v[158:159], v[154:155], v[150:151] op_sel:[0,0] op_sel_hi:[0,1]
    v_cvt_pk_bf16_f32 v70, v112, v114
    v_cvt_pk_bf16_f32 v82, -v113, -v115
    v_cvt_pk_bf16_f32 v140, v152, v154
    v_cvt_pk_bf16_f32 v144, v153, v155
    v_pk_fma_f32 v[156:157], v[152:153], v[150:151], v[156:157] op_sel:[1,1,0] op_sel_hi:[1,0,1] neg_lo:[1,0,0]
    v_cvt_pk_bf16_f32 v72, v120, v122
    v_cvt_pk_bf16_f32 v84, -v121, -v123
    v_pk_fma_f32 v[158:159], v[154:155], v[150:151], v[158:159] op_sel:[1,1,0] op_sel_hi:[1,0,1] neg_lo:[1,0,0]
    v_pk_mul_f32 v[152:153], v[156:157], v[150:151] op_sel:[0,0] op_sel_hi:[0,1]
    v_pk_mul_f32 v[154:155], v[158:159], v[150:151] op_sel:[0,0] op_sel_hi:[0,1]
    v_pk_mul_f32 v[126:127], v[124:125], v[44:45] op_sel:[0,0] op_sel_hi:[0,1]
    v_cvt_pk_bf16_f32 v71, v116, v118
    v_cvt_pk_bf16_f32 v141, v156, v158
    v_cvt_pk_bf16_f32 v145, v157, v159
    v_pk_fma_f32 v[152:153], v[156:157], v[150:151], v[152:153] op_sel:[1,1,0] op_sel_hi:[1,0,1] neg_lo:[1,0,0]
    v_cvt_pk_bf16_f32 v83, -v117, -v119
    v_pk_fma_f32 v[126:127], v[124:125], v[44:45], v[126:127] op_sel:[1,1,0] op_sel_hi:[1,0,1] neg_lo:[1,0,0]
    v_pk_fma_f32 v[154:155], v[158:159], v[150:151], v[154:155] op_sel:[1,1,0] op_sel_hi:[1,0,1] neg_lo:[1,0,0]
    v_pk_mul_f32 v[156:157], v[152:153], v[150:151] op_sel:[0,0] op_sel_hi:[0,1]
    v_pk_mul_f32 v[158:159], v[154:155], v[150:151] op_sel:[0,0] op_sel_hi:[0,1]
    ds_write_b128 v62, v[68:71] offset:16
    ds_write_b128 v62, v[80:83] offset:14352
    v_cvt_pk_bf16_f32 v142, v152, v154
    v_cvt_pk_bf16_f32 v146, v153, v155
    v_pk_fma_f32 v[156:157], v[152:153], v[150:151], v[156:157] op_sel:[1,1,0] op_sel_hi:[1,0,1] neg_lo:[1,0,0]
    v_pk_mul_f32 v[128:129], v[126:127], v[44:45] op_sel:[0,0] op_sel_hi:[0,1]
    v_cvt_pk_bf16_f32 v73, v124, v126
    v_pk_fma_f32 v[158:159], v[154:155], v[150:151], v[158:159] op_sel:[1,1,0] op_sel_hi:[1,0,1] neg_lo:[1,0,0]
    v_cvt_pk_bf16_f32 v143, v156, v158
    v_cvt_pk_bf16_f32 v147, v157, v159
    v_cvt_pk_bf16_f32 v85, -v125, -v127
    v_pk_fma_f32 v[128:129], v[126:127], v[44:45], v[128:129] op_sel:[1,1,0] op_sel_hi:[1,0,1] neg_lo:[1,0,0]
    ds_write_b128 v62, v[140:143] offset:96
    ds_write_b128 v62, v[144:147] offset:14432
    v_cvt_pk_bf16_f32 v74, v128, v128
    v_cvt_pk_bf16_f32 v86, -v129, -v129
    ds_write_b128 v62, v[72:75] offset:32
    ds_write_b128 v62, v[84:87] offset:14368
    s_lshl_b32 s80, s78, 2
    s_add_u32 s80, s80, 160000
    v_mov_b32 v60, s80
    v_mov_b32 v61, s96
    ds_write_b32 v60, v61
    v_xor_b32 v60, 4, v60
    s_mov_b32 s99, 0x100000
    s_and_b32 s80, s78, 1
    v_or_b32 v58, s80, v0
    s_waitcnt vmcnt(0)
    v_lshlrev_b32 v59, 16, v59
    v_cmp_eq_u32 vcc, 0, v58
    s_nop 1
    v_cndmask_b32 v59, 0, v59, vcc
Lcs:
    ds_read_b32 v61, v60
    s_waitcnt lgkmcnt(0)
    v_readfirstlane_b32 s80, v61
    s_sub_u32 s99, s99, 1
    s_cbranch_scc1 Lcsd
    s_cmp_lg_u32 s80, s96
    s_cbranch_scc1 Lcs
Lcsd:
    ds_read_b64_tr_b16 a[0:1], v52 offset:0
    ds_read_b64_tr_b16 a[4:5], v52 offset:32
    ds_read_b64_tr_b16 a[8:9], v53 offset:0
    ds_read_b64_tr_b16 a[2:3], v52 offset:1792
    ds_read_b64_tr_b16 a[6:7], v52 offset:1824
    ds_read_b64_tr_b16 a[10:11], v53 offset:1792
    ds_read_b64_tr_b16 a[12:13], v52 offset:3584
    ds_read_b64_tr_b16 a[16:17], v52 offset:3616
    ds_read_b64_tr_b16 a[20:21], v53 offset:3584
    ds_read_b64_tr_b16 a[14:15], v52 offset:5376
    ds_read_b64_tr_b16 a[18:19], v52 offset:5408
    ds_read_b64_tr_b16 a[22:23], v53 offset:5376
    ds_read_b64_tr_b16 a[24:25], v52 offset:7168
    ds_read_b64_tr_b16 a[28:29], v52 offset:7200
    ds_read_b64_tr_b16 a[32:33], v53 offset:7168
    ds_read_b64_tr_b16 a[26:27], v52 offset:8960
    ds_read_b64_tr_b16 a[30:31], v52 offset:8992
    ds_read_b64_tr_b16 a[34:35], v53 offset:8960
    s_waitcnt lgkmcnt(12)
    v_mfma_f32_16x16x32_bf16 v[32:35], a[0:3], a[8:11], 0
    v_mfma_f32_16x16x32_bf16 v[36:39], a[4:7], a[8:11], 0
    ds_read_b64_tr_b16 a[36:37], v52 offset:10752
    ds_read_b64_tr_b16 a[40:41], v52 offset:10784
    ds_read_b64_tr_b16 a[44:45], v53 offset:10752
    ds_read_b64_tr_b16 a[38:39], v52 offset:12544
    ds_read_b64_tr_b16 a[42:43], v52 offset:12576
    ds_read_b64_tr_b16 a[46:47], v53 offset:12544
    s_waitcnt lgkmcnt(12)
    v_mfma_f32_16x16x32_bf16 v[32:35], a[12:15], a[20:23], v[32:35]
    v_mfma_f32_16x16x32_bf16 v[36:39], a[16:19], a[20:23], v[36:39]
    ds_read_b64_tr_b16 a[48:49], v52 offset:14336
    ds_read_b64_tr_b16 a[52:53], v52 offset:14368
    ds_read_b64_tr_b16 a[56:57], v53 offset:14336
    ds_read_b64_tr_b16 a[50:51], v52 offset:16128
    ds_read_b64_tr_b16 a[54:55], v52 offset:16160
    ds_read_b64_tr_b16 a[58:59], v53 offset:16128
    s_waitcnt lgkmcnt(12)
    v_mfma_f32_16x16x32_bf16 v[32:35], a[24:27], a[32:35], v[32:35]
    v_mfma_f32_16x16x32_bf16 v[36:39], a[28:31], a[32:35], v[36:39]
    ds_read_b64_tr_b16 a[60:61], v52 offset:17920
    ds_read_b64_tr_b16 a[64:65], v52 offset:17952
    ds_read_b64_tr_b16 a[68:69], v53 offset:17920
    ds_read_b64_tr_b16 a[62:63], v52 offset:19712
    ds_read_b64_tr_b16 a[66:67], v52 offset:19744
    ds_read_b64_tr_b16 a[70:71], v53 offset:19712
    s_waitcnt lgkmcnt(12)
    v_mfma_f32_16x16x32_bf16 v[32:35], a[36:39], a[44:47], v[32:35]
    v_mfma_f32_16x16x32_bf16 v[36:39], a[40:43], a[44:47], v[36:39]
    ds_read_b64_tr_b16 a[72:73], v52 offset:21504
    ds_read_b64_tr_b16 a[76:77], v52 offset:21536
    ds_read_b64_tr_b16 a[80:81], v53 offset:21504
    ds_read_b64_tr_b16 a[74:75], v52 offset:23296
    ds_read_b64_tr_b16 a[78:79], v52 offset:23328
    ds_read_b64_tr_b16 a[82:83], v53 offset:23296
    s_waitcnt lgkmcnt(12)
    v_mfma_f32_16x16x32_bf16 v[32:35], a[48:51], a[56:59], v[32:35]
    v_mfma_f32_16x16x32_bf16 v[36:39], a[52:55], a[56:59], v[36:39]
    ds_read_b64_tr_b16 a[84:85], v52 offset:25088
    ds_read_b64_tr_b16 a[88:89], v52 offset:25120
    ds_read_b64_tr_b16 a[92:93], v53 offset:25088
    ds_read_b64_tr_b16 a[86:87], v52 offset:26880
    ds_read_b64_tr_b16 a[90:91], v52 offset:26912
    ds_read_b64_tr_b16 a[94:95], v53 offset:26880
    s_waitcnt lgkmcnt(12)
    v_mfma_f32_16x16x32_bf16 v[32:35], a[60:63], a[68:71], v[32:35]
    v_mfma_f32_16x16x32_bf16 v[36:39], a[64:67], a[68:71], v[36:39]
    s_waitcnt lgkmcnt(6)
    v_mfma_f32_16x16x32_bf16 v[32:35], a[72:75], a[80:83], v[32:35]
    v_mfma_f32_16x16x32_bf16 v[36:39], a[76:79], a[80:83], v[36:39]
    s_waitcnt lgkmcnt(0)
    v_mfma_f32_16x16x32_bf16 v[32:35], a[84:87], a[92:95], v[32:35]
    v_mfma_f32_16x16x32_bf16 v[36:39], a[88:91], a[92:95], v[36:39]
    s_nop 6
    v_add_f32 v32, v32, v59
    v_cvt_pk_bf16_f32 v32, v32, v33
    v_cvt_pk_bf16_f32 v33, v34, v35
    v_cvt_pk_bf16_f32 v34, v36, v37
    v_cvt_pk_bf16_f32 v35, v38, v39
    ds_write_b32 v54, v32
    ds_write_b32 v55, v33
    s_mov_b32 exec_hi, 0
    ds_write_b16 v56, v34
    ds_write_b16_d16_hi v56, v34 offset:64
    ds_write_b16 v56, v35 offset:128
    ds_write_b16_d16_hi v56, v35 offset:192
    s_mov_b32 exec_hi, -1
    s_waitcnt lgkmcnt(0)
    s_cmp_ge_u32 s77, 28
    s_cbranch_scc1 Lnog1
    s_barrier
    ds_read_b64_tr_b16 a[16:17], v10 offset:0
    ds_read_b64_tr_b16 a[18:19], v10 offset:1024
    ds_read_b128 a[0:3], v8 offset:0
    ds_read_b128 a[4:7], v8 offset:2048
    ds_read_b128 a[8:11], v8 offset:4096
    ds_read_b128 a[12:15], v8 offset:6144
    ds_read_b64_tr_b16 a[32:33], v10 offset:16384
    ds_read_b64_tr_b16 a[34:35], v10 offset:17408
    ds_read_b64_tr_b16 a[20:21], v11 offset:0
    ds_read_b64_tr_b16 a[22:23], v11 offset:1024
    ds_read_b64_tr_b16 a[36:37], v11 offset:16384
    ds_read_b64_tr_b16 a[38:39], v11 offset:17408
    ds_read_b64_tr_b16 a[24:25], v12 offset:0
    ds_read_b64_tr_b16 a[26:27], v12 offset:1024
    ds_read_b64_tr_b16 a[40:41], v12 offset:16384
    ds_read_b64_tr_b16 a[42:43], v12 offset:17408
    ds_read_b64_tr_b16 a[28:29], v13 offset:0
    ds_read_b64_tr_b16 a[30:31], v13 offset:1024
    ds_read_b64_tr_b16 a[44:45], v13 offset:16384
    ds_read_b64_tr_b16 a[46:47], v13 offset:17408
    s_waitcnt lgkmcnt(15)
    v_mfma_f32_16x16x32_bf16 v[32:35], a[16:19], a[0:3], 0
    ds_read_b64_tr_b16 a[64:65], v10 offset:8192
    s_waitcnt lgkmcnt(15)
    v_mfma_f32_16x16x32_bf16 v[36:39], a[16:19], a[4:7], 0
    ds_read_b64_tr_b16 a[66:67], v10 offset:9216
    s_waitcnt lgkmcnt(15)
    v_mfma_f32_16x16x32_bf16 v[40:43], a[16:19], a[8:11], 0
    ds_read_b128 a[48:51], v9 offset:0
    s_waitcnt lgkmcnt(15)
    v_mfma_f32_16x16x32_bf16 v[44:47], a[16:19], a[12:15], 0
    ds_read_b128 a[52:55], v9 offset:2048
    s_waitcnt lgkmcnt(15)
    v_mfma_f32_16x16x32_bf16 v[96:99], a[32:35], a[0:3], 0
    ds_read_b128 a[56:59], v9 offset:4096
    v_mfma_f32_16x16x32_bf16 v[100:103], a[32:35], a[4:7], 0
    ds_read_b128 a[60:63], v9 offset:6144
    v_mfma_f32_16x16x32_bf16 v[104:107], a[32:35], a[8:11], 0
    ds_read_b64_tr_b16 a[80:81], v10 offset:24576
    v_mfma_f32_16x16x32_bf16 v[108:111], a[32:35], a[12:15], 0
    ds_read_b64_tr_b16 a[82:83], v10 offset:25600
    s_waitcnt lgkmcnt(15)
    v_mfma_f32_16x16x32_bf16 v[48:51], a[20:23], a[0:3], 0
    ds_read_b64_tr_b16 a[68:69], v11 offset:8192
    v_mfma_f32_16x16x32_bf16 v[52:55], a[20:23], a[4:7], 0
    ds_read_b64_tr_b16 a[70:71], v11 offset:9216
    v_mfma_f32_16x16x32_bf16 v[56:59], a[20:23], a[8:11], 0
    ds_read_b64_tr_b16 a[84:85], v11 offset:24576
    v_mfma_f32_16x16x32_bf16 v[60:63], a[20:23], a[12:15], 0
    ds_read_b64_tr_b16 a[86:87], v11 offset:25600
    s_waitcnt lgkmcnt(15)
    v_mfma_f32_16x16x32_bf16 v[112:115], a[36:39], a[0:3], 0
    ds_read_b64_tr_b16 a[72:73], v12 offset:8192
    v_mfma_f32_16x16x32_bf16 v[116:119], a[36:39], a[4:7], 0
    ds_read_b64_tr_b16 a[74:75], v12 offset:9216
    v_mfma_f32_16x16x32_bf16 v[120:123], a[36:39], a[8:11], 0
    ds_read_b64_tr_b16 a[88:89], v12 offset:24576
    v_mfma_f32_16x16x32_bf16 v[124:127], a[36:39], a[12:15], 0
    ds_read_b64_tr_b16 a[90:91], v12 offset:25600
    s_waitcnt lgkmcnt(15)
    v_mfma_f32_16x16x32_bf16 v[64:67], a[24:27], a[0:3], 0
    ds_read_b64_tr_b16 a[76:77], v13 offset:8192
    v_mfma_f32_16x16x32_bf16 v[68:71], a[24:27], a[4:7], 0
    ds_read_b64_tr_b16 a[78:79], v13 offset:9216
    v_mfma_f32_16x16x32_bf16 v[72:75], a[24:27], a[8:11], 0
    ds_read_b64_tr_b16 a[92:93], v13 offset:24576
    v_mfma_f32_16x16x32_bf16 v[76:79], a[24:27], a[12:15], 0
    ds_read_b64_tr_b16 a[94:95], v13 offset:25600
    s_waitcnt lgkmcnt(15)
    v_mfma_f32_16x16x32_bf16 v[128:131], a[40:43], a[0:3], 0
    v_mfma_f32_16x16x32_bf16 v[132:135], a[40:43], a[4:7], 0
    v_mfma_f32_16x16x32_bf16 v[136:139], a[40:43], a[8:11], 0
    v_mfma_f32_16x16x32_bf16 v[140:143], a[40:43], a[12:15], 0
    v_mfma_f32_16x16x32_bf16 v[80:83], a[28:31], a[0:3], 0
    v_mfma_f32_16x16x32_bf16 v[84:87], a[28:31], a[4:7], 0
    v_mfma_f32_16x16x32_bf16 v[88:91], a[28:31], a[8:11], 0
    v_mfma_f32_16x16x32_bf16 v[92:95], a[28:31], a[12:15], 0
    v_mfma_f32_16x16x32_bf16 v[144:147], a[44:47], a[0:3], 0
    v_mfma_f32_16x16x32_bf16 v[148:151], a[44:47], a[4:7], 0
    v_mfma_f32_16x16x32_bf16 v[152:155], a[44:47], a[8:11], 0
    v_mfma_f32_16x16x32_bf16 v[156:159], a[44:47], a[12:15], 0
    v_mfma_f32_16x16x32_bf16 v[32:35], a[64:67], a[48:51], v[32:35]
    v_mfma_f32_16x16x32_bf16 v[36:39], a[64:67], a[52:55], v[36:39]
    v_mfma_f32_16x16x32_bf16 v[40:43], a[64:67], a[56:59], v[40:43]
    s_waitcnt lgkmcnt(14)
    v_mfma_f32_16x16x32_bf16 v[44:47], a[64:67], a[60:63], v[44:47]
    s_waitcnt lgkmcnt(12)
    v_mfma_f32_16x16x32_bf16 v[96:99], a[80:83], a[48:51], v[96:99]
    v_mfma_f32_16x16x32_bf16 v[100:103], a[80:83], a[52:55], v[100:103]
    v_mfma_f32_16x16x32_bf16 v[104:107], a[80:83], a[56:59], v[104:107]
    v_mfma_f32_16x16x32_bf16 v[108:111], a[80:83], a[60:63], v[108:111]
    s_waitcnt lgkmcnt(0)
    s_barrier
    v_mfma_f32_16x16x32_bf16 v[48:51], a[68:71], a[48:51], v[48:51]
    ds_read_b64_tr_b16 a[16:17], v16 offset:0
    v_mfma_f32_16x16x32_bf16 v[52:55], a[68:71], a[52:55], v[52:55]
    ds_read_b64_tr_b16 a[18:19], v16 offset:1024
    v_mfma_f32_16x16x32_bf16 v[56:59], a[68:71], a[56:59], v[56:59]
    ds_read_b128 a[0:3], v14 offset:0
    v_mfma_f32_16x16x32_bf16 v[60:63], a[68:71], a[60:63], v[60:63]
    ds_read_b128 a[4:7], v14 offset:2048
    v_mfma_f32_16x16x32_bf16 v[112:115], a[84:87], a[48:51], v[112:115]
    ds_read_b128 a[8:11], v14 offset:4096
    v_mfma_f32_16x16x32_bf16 v[116:119], a[84:87], a[52:55], v[116:119]
    ds_read_b128 a[12:15], v14 offset:6144
    v_mfma_f32_16x16x32_bf16 v[120:123], a[84:87], a[56:59], v[120:123]
    ds_read_b64_tr_b16 a[32:33], v16 offset:16384
    v_mfma_f32_16x16x32_bf16 v[124:127], a[84:87], a[60:63], v[124:127]
    ds_read_b64_tr_b16 a[34:35], v16 offset:17408
    v_mfma_f32_16x16x32_bf16 v[64:67], a[72:75], a[48:51], v[64:67]
    ds_read_b64_tr_b16 a[20:21], v17 offset:0
    v_mfma_f32_16x16x32_bf16 v[68:71], a[72:75], a[52:55], v[68:71]
    ds_read_b64_tr_b16 a[22:23], v17 offset:1024
    v_mfma_f32_16x16x32_bf16 v[72:75], a[72:75], a[56:59], v[72:75]
    ds_read_b64_tr_b16 a[36:37], v17 offset:16384
    v_mfma_f32_16x16x32_bf16 v[76:79], a[72:75], a[60:63], v[76:79]
    ds_read_b64_tr_b16 a[38:39], v17 offset:17408
    v_mfma_f32_16x16x32_bf16 v[128:131], a[88:91], a[48:51], v[128:131]
    ds_read_b64_tr_b16 a[24:25], v18 offset:0
    v_mfma_f32_16x16x32_bf16 v[132:135], a[88:91], a[52:55], v[132:135]
    ds_read_b64_tr_b16 a[26:27], v18 offset:1024
    v_mfma_f32_16x16x32_bf16 v[136:139], a[88:91], a[56:59], v[136:139]
    ds_read_b64_tr_b16 a[40:41], v18 offset:16384
    v_mfma_f32_16x16x32_bf16 v[140:143], a[88:91], a[60:63], v[140:143]
    ds_read_b64_tr_b16 a[42:43], v18 offset:17408
    s_waitcnt lgkmcnt(15)
    v_mfma_f32_16x16x32_bf16 v[80:83], a[76:79], a[48:51], v[80:83]
    ds_read_b64_tr_b16 a[28:29], v19 offset:0
    v_mfma_f32_16x16x32_bf16 v[84:87], a[76:79], a[52:55], v[84:87]
    ds_read_b64_tr_b16 a[30:31], v19 offset:1024
    v_mfma_f32_16x16x32_bf16 v[88:91], a[76:79], a[56:59], v[88:91]
    ds_read_b64_tr_b16 a[44:45], v19 offset:16384
    v_mfma_f32_16x16x32_bf16 v[92:95], a[76:79], a[60:63], v[92:95]
    ds_read_b64_tr_b16 a[46:47], v19 offset:17408
    s_waitcnt lgkmcnt(15)
    v_mfma_f32_16x16x32_bf16 v[144:147], a[92:95], a[48:51], v[144:147]
    v_mfma_f32_16x16x32_bf16 v[148:151], a[92:95], a[52:55], v[148:151]
    v_mfma_f32_16x16x32_bf16 v[152:155], a[92:95], a[56:59], v[152:155]
    v_mfma_f32_16x16x32_bf16 v[156:159], a[92:95], a[60:63], v[156:159]
    v_mfma_f32_16x16x32_bf16 v[32:35], a[16:19], a[0:3], v[32:35]
    ds_read_b64_tr_b16 a[64:65], v16 offset:8192
    s_waitcnt lgkmcnt(15)
    v_mfma_f32_16x16x32_bf16 v[36:39], a[16:19], a[4:7], v[36:39]
    ds_read_b64_tr_b16 a[66:67], v16 offset:9216
    s_waitcnt lgkmcnt(15)
    v_mfma_f32_16x16x32_bf16 v[40:43], a[16:19], a[8:11], v[40:43]
    ds_read_b128 a[48:51], v15 offset:0
    s_waitcnt lgkmcnt(15)
    v_mfma_f32_16x16x32_bf16 v[44:47], a[16:19], a[12:15], v[44:47]
    ds_read_b128 a[52:55], v15 offset:2048
    s_waitcnt lgkmcnt(15)
    v_mfma_f32_16x16x32_bf16 v[96:99], a[32:35], a[0:3], v[96:99]
    ds_read_b128 a[56:59], v15 offset:4096
    v_mfma_f32_16x16x32_bf16 v[100:103], a[32:35], a[4:7], v[100:103]
    ds_read_b128 a[60:63], v15 offset:6144
    v_mfma_f32_16x16x32_bf16 v[104:107], a[32:35], a[8:11], v[104:107]
    ds_read_b64_tr_b16 a[80:81], v16 offset:24576
    v_mfma_f32_16x16x32_bf16 v[108:111], a[32:35], a[12:15], v[108:111]
    ds_read_b64_tr_b16 a[82:83], v16 offset:25600
    s_waitcnt lgkmcnt(15)
    v_mfma_f32_16x16x32_bf16 v[48:51], a[20:23], a[0:3], v[48:51]
    ds_read_b64_tr_b16 a[68:69], v17 offset:8192
    v_mfma_f32_16x16x32_bf16 v[52:55], a[20:23], a[4:7], v[52:55]
    ds_read_b64_tr_b16 a[70:71], v17 offset:9216
    v_mfma_f32_16x16x32_bf16 v[56:59], a[20:23], a[8:11], v[56:59]
    ds_read_b64_tr_b16 a[84:85], v17 offset:24576
    v_mfma_f32_16x16x32_bf16 v[60:63], a[20:23], a[12:15], v[60:63]
    ds_read_b64_tr_b16 a[86:87], v17 offset:25600
    s_waitcnt lgkmcnt(15)
    v_mfma_f32_16x16x32_bf16 v[112:115], a[36:39], a[0:3], v[112:115]
    ds_read_b64_tr_b16 a[72:73], v18 offset:8192
    v_mfma_f32_16x16x32_bf16 v[116:119], a[36:39], a[4:7], v[116:119]
    ds_read_b64_tr_b16 a[74:75], v18 offset:9216
    v_mfma_f32_16x16x32_bf16 v[120:123], a[36:39], a[8:11], v[120:123]
    ds_read_b64_tr_b16 a[88:89], v18 offset:24576
    v_mfma_f32_16x16x32_bf16 v[124:127], a[36:39], a[12:15], v[124:127]
    ds_read_b64_tr_b16 a[90:91], v18 offset:25600
    s_waitcnt lgkmcnt(15)
    v_mfma_f32_16x16x32_bf16 v[64:67], a[24:27], a[0:3], v[64:67]
    ds_read_b64_tr_b16 a[76:77], v19 offset:8192
    v_mfma_f32_16x16x32_bf16 v[68:71], a[24:27], a[4:7], v[68:71]
    ds_read_b64_tr_b16 a[78:79], v19 offset:9216
    v_mfma_f32_16x16x32_bf16 v[72:75], a[24:27], a[8:11], v[72:75]
    ds_read_b64_tr_b16 a[92:93], v19 offset:24576
    v_mfma_f32_16x16x32_bf16 v[76:79], a[24:27], a[12:15], v[76:79]
    ds_read_b64_tr_b16 a[94:95], v19 offset:25600
    s_waitcnt lgkmcnt(15)
    v_mfma_f32_16x16x32_bf16 v[128:131], a[40:43], a[0:3], v[128:131]
    v_mfma_f32_16x16x32_bf16 v[132:135], a[40:43], a[4:7], v[132:135]
    v_mfma_f32_16x16x32_bf16 v[136:139], a[40:43], a[8:11], v[136:139]
    v_mfma_f32_16x16x32_bf16 v[140:143], a[40:43], a[12:15], v[140:143]
    v_mfma_f32_16x16x32_bf16 v[80:83], a[28:31], a[0:3], v[80:83]
    v_mfma_f32_16x16x32_bf16 v[84:87], a[28:31], a[4:7], v[84:87]
    v_mfma_f32_16x16x32_bf16 v[88:91], a[28:31], a[8:11], v[88:91]
    v_mfma_f32_16x16x32_bf16 v[92:95], a[28:31], a[12:15], v[92:95]
    v_mfma_f32_16x16x32_bf16 v[144:147], a[44:47], a[0:3], v[144:147]
    v_mfma_f32_16x16x32_bf16 v[148:151], a[44:47], a[4:7], v[148:151]
    v_mfma_f32_16x16x32_bf16 v[152:155], a[44:47], a[8:11], v[152:155]
    v_mfma_f32_16x16x32_bf16 v[156:159], a[44:47], a[12:15], v[156:159]
    v_mfma_f32_16x16x32_bf16 v[32:35], a[64:67], a[48:51], v[32:35]
    v_mfma_f32_16x16x32_bf16 v[36:39], a[64:67], a[52:55], v[36:39]
    v_mfma_f32_16x16x32_bf16 v[40:43], a[64:67], a[56:59], v[40:43]
    s_waitcnt lgkmcnt(14)
    v_mfma_f32_16x16x32_bf16 v[44:47], a[64:67], a[60:63], v[44:47]
    s_waitcnt lgkmcnt(12)
    v_mfma_f32_16x16x32_bf16 v[96:99], a[80:83], a[48:51], v[96:99]
    v_mfma_f32_16x16x32_bf16 v[100:103], a[80:83], a[52:55], v[100:103]
    v_mfma_f32_16x16x32_bf16 v[104:107], a[80:83], a[56:59], v[104:107]
    v_mfma_f32_16x16x32_bf16 v[108:111], a[80:83], a[60:63], v[108:111]
    s_waitcnt lgkmcnt(0)
    s_barrier
    v_mfma_f32_16x16x32_bf16 v[48:51], a[68:71], a[48:51], v[48:51]
    ds_read_b64_tr_b16 a[16:17], v22 offset:0
    v_mfma_f32_16x16x32_bf16 v[52:55], a[68:71], a[52:55], v[52:55]
    ds_read_b64_tr_b16 a[18:19], v22 offset:1024
    v_mfma_f32_16x16x32_bf16 v[56:59], a[68:71], a[56:59], v[56:59]
    ds_read_b128 a[0:3], v20 offset:0
    v_mfma_f32_16x16x32_bf16 v[60:63], a[68:71], a[60:63], v[60:63]
    ds_read_b128 a[4:7], v20 offset:2048
    v_mfma_f32_16x16x32_bf16 v[112:115], a[84:87], a[48:51], v[112:115]
    ds_read_b128 a[8:11], v20 offset:4096
    v_mfma_f32_16x16x32_bf16 v[116:119], a[84:87], a[52:55], v[116:119]
    ds_read_b128 a[12:15], v20 offset:6144
    v_mfma_f32_16x16x32_bf16 v[120:123], a[84:87], a[56:59], v[120:123]
    ds_read_b64_tr_b16 a[32:33], v22 offset:16384
    v_mfma_f32_16x16x32_bf16 v[124:127], a[84:87], a[60:63], v[124:127]
    ds_read_b64_tr_b16 a[34:35], v22 offset:17408
    v_mfma_f32_16x16x32_bf16 v[64:67], a[72:75], a[48:51], v[64:67]
    ds_read_b64_tr_b16 a[20:21], v23 offset:0
    v_mfma_f32_16x16x32_bf16 v[68:71], a[72:75], a[52:55], v[68:71]
    ds_read_b64_tr_b16 a[22:23], v23 offset:1024
    v_mfma_f32_16x16x32_bf16 v[72:75], a[72:75], a[56:59], v[72:75]
    ds_read_b64_tr_b16 a[36:37], v23 offset:16384
    v_mfma_f32_16x16x32_bf16 v[76:79], a[72:75], a[60:63], v[76:79]
    ds_read_b64_tr_b16 a[38:39], v23 offset:17408
    v_mfma_f32_16x16x32_bf16 v[128:131], a[88:91], a[48:51], v[128:131]
    ds_read_b64_tr_b16 a[24:25], v24 offset:0
    v_mfma_f32_16x16x32_bf16 v[132:135], a[88:91], a[52:55], v[132:135]
    ds_read_b64_tr_b16 a[26:27], v24 offset:1024
    v_mfma_f32_16x16x32_bf16 v[136:139], a[88:91], a[56:59], v[136:139]
    ds_read_b64_tr_b16 a[40:41], v24 offset:16384
    v_mfma_f32_16x16x32_bf16 v[140:143], a[88:91], a[60:63], v[140:143]
    ds_read_b64_tr_b16 a[42:43], v24 offset:17408
    s_waitcnt lgkmcnt(15)
    v_mfma_f32_16x16x32_bf16 v[80:83], a[76:79], a[48:51], v[80:83]
    ds_read_b64_tr_b16 a[28:29], v25 offset:0
    v_mfma_f32_16x16x32_bf16 v[84:87], a[76:79], a[52:55], v[84:87]
    ds_read_b64_tr_b16 a[30:31], v25 offset:1024
    v_mfma_f32_16x16x32_bf16 v[88:91], a[76:79], a[56:59], v[88:91]
    ds_read_b64_tr_b16 a[44:45], v25 offset:16384
    v_mfma_f32_16x16x32_bf16 v[92:95], a[76:79], a[60:63], v[92:95]
    ds_read_b64_tr_b16 a[46:47], v25 offset:17408
    s_waitcnt lgkmcnt(15)
    v_mfma_f32_16x16x32_bf16 v[144:147], a[92:95], a[48:51], v[144:147]
    v_mfma_f32_16x16x32_bf16 v[148:151], a[92:95], a[52:55], v[148:151]
    v_mfma_f32_16x16x32_bf16 v[152:155], a[92:95], a[56:59], v[152:155]
    v_mfma_f32_16x16x32_bf16 v[156:159], a[92:95], a[60:63], v[156:159]
    v_mfma_f32_16x16x32_bf16 v[32:35], a[16:19], a[0:3], v[32:35]
    ds_read_b64_tr_b16 a[64:65], v22 offset:8192
    s_waitcnt lgkmcnt(15)
    v_mfma_f32_16x16x32_bf16 v[36:39], a[16:19], a[4:7], v[36:39]
    ds_read_b64_tr_b16 a[66:67], v22 offset:9216
    s_waitcnt lgkmcnt(15)
    v_mfma_f32_16x16x32_bf16 v[40:43], a[16:19], a[8:11], v[40:43]
    ds_read_b128 a[48:51], v21 offset:0
    s_waitcnt lgkmcnt(15)
    v_mfma_f32_16x16x32_bf16 v[44:47], a[16:19], a[12:15], v[44:47]
    ds_read_b128 a[52:55], v21 offset:2048
    s_waitcnt lgkmcnt(15)
    v_mfma_f32_16x16x32_bf16 v[96:99], a[32:35], a[0:3], v[96:99]
    ds_read_b128 a[56:59], v21 offset:4096
    v_mfma_f32_16x16x32_bf16 v[100:103], a[32:35], a[4:7], v[100:103]
    ds_read_b128 a[60:63], v21 offset:6144
    v_mfma_f32_16x16x32_bf16 v[104:107], a[32:35], a[8:11], v[104:107]
    ds_read_b64_tr_b16 a[80:81], v22 offset:24576
    v_mfma_f32_16x16x32_bf16 v[108:111], a[32:35], a[12:15], v[108:111]
    ds_read_b64_tr_b16 a[82:83], v22 offset:25600
    s_waitcnt lgkmcnt(15)
    v_mfma_f32_16x16x32_bf16 v[48:51], a[20:23], a[0:3], v[48:51]
    ds_read_b64_tr_b16 a[68:69], v23 offset:8192
    v_mfma_f32_16x16x32_bf16 v[52:55], a[20:23], a[4:7], v[52:55]
    ds_read_b64_tr_b16 a[70:71], v23 offset:9216
    v_mfma_f32_16x16x32_bf16 v[56:59], a[20:23], a[8:11], v[56:59]
    ds_read_b64_tr_b16 a[84:85], v23 offset:24576
    v_mfma_f32_16x16x32_bf16 v[60:63], a[20:23], a[12:15], v[60:63]
    ds_read_b64_tr_b16 a[86:87], v23 offset:25600
    s_waitcnt lgkmcnt(15)
    v_mfma_f32_16x16x32_bf16 v[112:115], a[36:39], a[0:3], v[112:115]
    ds_read_b64_tr_b16 a[72:73], v24 offset:8192
    v_mfma_f32_16x16x32_bf16 v[116:119], a[36:39], a[4:7], v[116:119]
    ds_read_b64_tr_b16 a[74:75], v24 offset:9216
    v_mfma_f32_16x16x32_bf16 v[120:123], a[36:39], a[8:11], v[120:123]
    ds_read_b64_tr_b16 a[88:89], v24 offset:24576
    v_mfma_f32_16x16x32_bf16 v[124:127], a[36:39], a[12:15], v[124:127]
    ds_read_b64_tr_b16 a[90:91], v24 offset:25600
    s_waitcnt lgkmcnt(15)
    v_mfma_f32_16x16x32_bf16 v[64:67], a[24:27], a[0:3], v[64:67]
    ds_read_b64_tr_b16 a[76:77], v25 offset:8192
    v_mfma_f32_16x16x32_bf16 v[68:71], a[24:27], a[4:7], v[68:71]
    ds_read_b64_tr_b16 a[78:79], v25 offset:9216
    v_mfma_f32_16x16x32_bf16 v[72:75], a[24:27], a[8:11], v[72:75]
    ds_read_b64_tr_b16 a[92:93], v25 offset:24576
    v_mfma_f32_16x16x32_bf16 v[76:79], a[24:27], a[12:15], v[76:79]
    ds_read_b64_tr_b16 a[94:95], v25 offset:25600
    s_waitcnt lgkmcnt(15)
    v_mfma_f32_16x16x32_bf16 v[128:131], a[40:43], a[0:3], v[128:131]
    v_mfma_f32_16x16x32_bf16 v[132:135], a[40:43], a[4:7], v[132:135]
    v_mfma_f32_16x16x32_bf16 v[136:139], a[40:43], a[8:11], v[136:139]
    v_mfma_f32_16x16x32_bf16 v[140:143], a[40:43], a[12:15], v[140:143]
    v_mfma_f32_16x16x32_bf16 v[80:83], a[28:31], a[0:3], v[80:83]
    v_mfma_f32_16x16x32_bf16 v[84:87], a[28:31], a[4:7], v[84:87]
    v_mfma_f32_16x16x32_bf16 v[88:91], a[28:31], a[8:11], v[88:91]
    v_mfma_f32_16x16x32_bf16 v[92:95], a[28:31], a[12:15], v[92:95]
    v_mfma_f32_16x16x32_bf16 v[144:147], a[44:47], a[0:3], v[144:147]
    v_mfma_f32_16x16x32_bf16 v[148:151], a[44:47], a[4:7], v[148:151]
    v_mfma_f32_16x16x32_bf16 v[152:155], a[44:47], a[8:11], v[152:155]
    v_mfma_f32_16x16x32_bf16 v[156:159], a[44:47], a[12:15], v[156:159]
    v_mfma_f32_16x16x32_bf16 v[32:35], a[64:67], a[48:51], v[32:35]
    v_mfma_f32_16x16x32_bf16 v[36:39], a[64:67], a[52:55], v[36:39]
    v_mfma_f32_16x16x32_bf16 v[40:43], a[64:67], a[56:59], v[40:43]
    s_waitcnt lgkmcnt(14)
    v_mfma_f32_16x16x32_bf16 v[44:47], a[64:67], a[60:63], v[44:47]
    s_waitcnt lgkmcnt(12)
    v_mfma_f32_16x16x32_bf16 v[96:99], a[80:83], a[48:51], v[96:99]
    v_mfma_f32_16x16x32_bf16 v[100:103], a[80:83], a[52:55], v[100:103]
    v_mfma_f32_16x16x32_bf16 v[104:107], a[80:83], a[56:59], v[104:107]
    v_mfma_f32_16x16x32_bf16 v[108:111], a[80:83], a[60:63], v[108:111]
    s_waitcnt lgkmcnt(0)
    s_barrier
    v_mfma_f32_16x16x32_bf16 v[48:51], a[68:71], a[48:51], v[48:51]
    ds_read_b64_tr_b16 a[16:17], v10 offset:0
    v_mfma_f32_16x16x32_bf16 v[52:55], a[68:71], a[52:55], v[52:55]
    ds_read_b64_tr_b16 a[18:19], v10 offset:1024
    v_mfma_f32_16x16x32_bf16 v[56:59], a[68:71], a[56:59], v[56:59]
    ds_read_b128 a[0:3], v8 offset:0
    v_mfma_f32_16x16x32_bf16 v[60:63], a[68:71], a[60:63], v[60:63]
    ds_read_b128 a[4:7], v8 offset:2048
    v_mfma_f32_16x16x32_bf16 v[112:115], a[84:87], a[48:51], v[112:115]
    ds_read_b128 a[8:11], v8 offset:4096
    v_mfma_f32_16x16x32_bf16 v[116:119], a[84:87], a[52:55], v[116:119]
    ds_read_b128 a[12:15], v8 offset:6144
    v_mfma_f32_16x16x32_bf16 v[120:123], a[84:87], a[56:59], v[120:123]
    ds_read_b64_tr_b16 a[32:33], v10 offset:16384
    v_mfma_f32_16x16x32_bf16 v[124:127], a[84:87], a[60:63], v[124:127]
    ds_read_b64_tr_b16 a[34:35], v10 offset:17408
    v_mfma_f32_16x16x32_bf16 v[64:67], a[72:75], a[48:51], v[64:67]
    ds_read_b64_tr_b16 a[20:21], v11 offset:0
    v_mfma_f32_16x16x32_bf16 v[68:71], a[72:75], a[52:55], v[68:71]
    ds_read_b64_tr_b16 a[22:23], v11 offset:1024
    v_mfma_f32_16x16x32_bf16 v[72:75], a[72:75], a[56:59], v[72:75]
    ds_read_b64_tr_b16 a[36:37], v11 offset:16384
    v_mfma_f32_16x16x32_bf16 v[76:79], a[72:75], a[60:63], v[76:79]
    ds_read_b64_tr_b16 a[38:39], v11 offset:17408
    v_mfma_f32_16x16x32_bf16 v[128:131], a[88:91], a[48:51], v[128:131]
    ds_read_b64_tr_b16 a[24:25], v12 offset:0
    v_mfma_f32_16x16x32_bf16 v[132:135], a[88:91], a[52:55], v[132:135]
    ds_read_b64_tr_b16 a[26:27], v12 offset:1024
    v_mfma_f32_16x16x32_bf16 v[136:139], a[88:91], a[56:59], v[136:139]
    ds_read_b64_tr_b16 a[40:41], v12 offset:16384
    v_mfma_f32_16x16x32_bf16 v[140:143], a[88:91], a[60:63], v[140:143]
    ds_read_b64_tr_b16 a[42:43], v12 offset:17408
    s_waitcnt lgkmcnt(15)
    v_mfma_f32_16x16x32_bf16 v[80:83], a[76:79], a[48:51], v[80:83]
    ds_read_b64_tr_b16 a[28:29], v13 offset:0
    v_mfma_f32_16x16x32_bf16 v[84:87], a[76:79], a[52:55], v[84:87]
    ds_read_b64_tr_b16 a[30:31], v13 offset:1024
    v_mfma_f32_16x16x32_bf16 v[88:91], a[76:79], a[56:59], v[88:91]
    ds_read_b64_tr_b16 a[44:45], v13 offset:16384
    v_mfma_f32_16x16x32_bf16 v[92:95], a[76:79], a[60:63], v[92:95]
    ds_read_b64_tr_b16 a[46:47], v13 offset:17408
    s_waitcnt lgkmcnt(15)
    v_mfma_f32_16x16x32_bf16 v[144:147], a[92:95], a[48:51], v[144:147]
    v_mfma_f32_16x16x32_bf16 v[148:151], a[92:95], a[52:55], v[148:151]
    v_mfma_f32_16x16x32_bf16 v[152:155], a[92:95], a[56:59], v[152:155]
    v_mfma_f32_16x16x32_bf16 v[156:159], a[92:95], a[60:63], v[156:159]
    v_mfma_f32_16x16x32_bf16 v[32:35], a[16:19], a[0:3], v[32:35]
    ds_read_b64_tr_b16 a[64:65], v10 offset:8192
    s_waitcnt lgkmcnt(15)
    v_mfma_f32_16x16x32_bf16 v[36:39], a[16:19], a[4:7], v[36:39]
    ds_read_b64_tr_b16 a[66:67], v10 offset:9216
    s_waitcnt lgkmcnt(15)
    v_mfma_f32_16x16x32_bf16 v[40:43], a[16:19], a[8:11], v[40:43]
    ds_read_b128 a[48:51], v9 offset:0
    s_waitcnt lgkmcnt(15)
    v_mfma_f32_16x16x32_bf16 v[44:47], a[16:19], a[12:15], v[44:47]
    ds_read_b128 a[52:55], v9 offset:2048
    s_waitcnt lgkmcnt(15)
    v_mfma_f32_16x16x32_bf16 v[96:99], a[32:35], a[0:3], v[96:99]
    ds_read_b128 a[56:59], v9 offset:4096
    v_mfma_f32_16x16x32_bf16 v[100:103], a[32:35], a[4:7], v[100:103]
    ds_read_b128 a[60:63], v9 offset:6144
    v_mfma_f32_16x16x32_bf16 v[104:107], a[32:35], a[8:11], v[104:107]
    ds_read_b64_tr_b16 a[80:81], v10 offset:24576
    v_mfma_f32_16x16x32_bf16 v[108:111], a[32:35], a[12:15], v[108:111]
    ds_read_b64_tr_b16 a[82:83], v10 offset:25600
    s_waitcnt lgkmcnt(15)
    v_mfma_f32_16x16x32_bf16 v[48:51], a[20:23], a[0:3], v[48:51]
    ds_read_b64_tr_b16 a[68:69], v11 offset:8192
    v_mfma_f32_16x16x32_bf16 v[52:55], a[20:23], a[4:7], v[52:55]
    ds_read_b64_tr_b16 a[70:71], v11 offset:9216
    v_mfma_f32_16x16x32_bf16 v[56:59], a[20:23], a[8:11], v[56:59]
    ds_read_b64_tr_b16 a[84:85], v11 offset:24576
    v_mfma_f32_16x16x32_bf16 v[60:63], a[20:23], a[12:15], v[60:63]
    ds_read_b64_tr_b16 a[86:87], v11 offset:25600
    s_waitcnt lgkmcnt(15)
    v_mfma_f32_16x16x32_bf16 v[112:115], a[36:39], a[0:3], v[112:115]
    ds_read_b64_tr_b16 a[72:73], v12 offset:8192
    v_mfma_f32_16x16x32_bf16 v[116:119], a[36:39], a[4:7], v[116:119]
    ds_read_b64_tr_b16 a[74:75], v12 offset:9216
    v_mfma_f32_16x16x32_bf16 v[120:123], a[36:39], a[8:11], v[120:123]
    ds_read_b64_tr_b16 a[88:89], v12 offset:24576
    v_mfma_f32_16x16x32_bf16 v[124:127], a[36:39], a[12:15], v[124:127]
    ds_read_b64_tr_b16 a[90:91], v12 offset:25600
    s_waitcnt lgkmcnt(15)
    v_mfma_f32_16x16x32_bf16 v[64:67], a[24:27], a[0:3], v[64:67]
    ds_read_b64_tr_b16 a[76:77], v13 offset:8192
    v_mfma_f32_16x16x32_bf16 v[68:71], a[24:27], a[4:7], v[68:71]
    ds_read_b64_tr_b16 a[78:79], v13 offset:9216
    v_mfma_f32_16x16x32_bf16 v[72:75], a[24:27], a[8:11], v[72:75]
    ds_read_b64_tr_b16 a[92:93], v13 offset:24576
    v_mfma_f32_16x16x32_bf16 v[76:79], a[24:27], a[12:15], v[76:79]
    ds_read_b64_tr_b16 a[94:95], v13 offset:25600
    s_waitcnt lgkmcnt(15)
    v_mfma_f32_16x16x32_bf16 v[128:131], a[40:43], a[0:3], v[128:131]
    v_mfma_f32_16x16x32_bf16 v[132:135], a[40:43], a[4:7], v[132:135]
    v_mfma_f32_16x16x32_bf16 v[136:139], a[40:43], a[8:11], v[136:139]
    v_mfma_f32_16x16x32_bf16 v[140:143], a[40:43], a[12:15], v[140:143]
    v_mfma_f32_16x16x32_bf16 v[80:83], a[28:31], a[0:3], v[80:83]
    v_mfma_f32_16x16x32_bf16 v[84:87], a[28:31], a[4:7], v[84:87]
    v_mfma_f32_16x16x32_bf16 v[88:91], a[28:31], a[8:11], v[88:91]
    v_mfma_f32_16x16x32_bf16 v[92:95], a[28:31], a[12:15], v[92:95]
    v_mfma_f32_16x16x32_bf16 v[144:147], a[44:47], a[0:3], v[144:147]
    v_mfma_f32_16x16x32_bf16 v[148:151], a[44:47], a[4:7], v[148:151]
    v_mfma_f32_16x16x32_bf16 v[152:155], a[44:47], a[8:11], v[152:155]
    v_mfma_f32_16x16x32_bf16 v[156:159], a[44:47], a[12:15], v[156:159]
    v_mfma_f32_16x16x32_bf16 v[32:35], a[64:67], a[48:51], v[32:35]
    v_mfma_f32_16x16x32_bf16 v[36:39], a[64:67], a[52:55], v[36:39]
    v_mfma_f32_16x16x32_bf16 v[40:43], a[64:67], a[56:59], v[40:43]
    s_waitcnt lgkmcnt(14)
    v_mfma_f32_16x16x32_bf16 v[44:47], a[64:67], a[60:63], v[44:47]
    s_waitcnt lgkmcnt(12)
    v_mfma_f32_16x16x32_bf16 v[96:99], a[80:83], a[48:51], v[96:99]
    v_mfma_f32_16x16x32_bf16 v[100:103], a[80:83], a[52:55], v[100:103]
    v_mfma_f32_16x16x32_bf16 v[104:107], a[80:83], a[56:59], v[104:107]
    v_mfma_f32_16x16x32_bf16 v[108:111], a[80:83], a[60:63], v[108:111]
    s_waitcnt lgkmcnt(0)
    s_barrier
    v_mfma_f32_16x16x32_bf16 v[48:51], a[68:71], a[48:51], v[48:51]
    ds_read_b64_tr_b16 a[16:17], v16 offset:0
    v_mfma_f32_16x16x32_bf16 v[52:55], a[68:71], a[52:55], v[52:55]
    ds_read_b64_tr_b16 a[18:19], v16 offset:1024
    v_mfma_f32_16x16x32_bf16 v[56:59], a[68:71], a[56:59], v[56:59]
    ds_read_b128 a[0:3], v14 offset:0
    v_mfma_f32_16x16x32_bf16 v[60:63], a[68:71], a[60:63], v[60:63]
    ds_read_b128 a[4:7], v14 offset:2048
    v_mfma_f32_16x16x32_bf16 v[112:115], a[84:87], a[48:51], v[112:115]
    ds_read_b128 a[8:11], v14 offset:4096
    v_mfma_f32_16x16x32_bf16 v[116:119], a[84:87], a[52:55], v[116:119]
    ds_read_b128 a[12:15], v14 offset:6144
    v_mfma_f32_16x16x32_bf16 v[120:123], a[84:87], a[56:59], v[120:123]
    ds_read_b64_tr_b16 a[32:33], v16 offset:16384
    v_mfma_f32_16x16x32_bf16 v[124:127], a[84:87], a[60:63], v[124:127]
    ds_read_b64_tr_b16 a[34:35], v16 offset:17408
    v_mfma_f32_16x16x32_bf16 v[64:67], a[72:75], a[48:51], v[64:67]
    ds_read_b64_tr_b16 a[20:21], v17 offset:0
    v_mfma_f32_16x16x32_bf16 v[68:71], a[72:75], a[52:55], v[68:71]
    ds_read_b64_tr_b16 a[22:23], v17 offset:1024
    v_mfma_f32_16x16x32_bf16 v[72:75], a[72:75], a[56:59], v[72:75]
    ds_read_b64_tr_b16 a[36:37], v17 offset:16384
    v_mfma_f32_16x16x32_bf16 v[76:79], a[72:75], a[60:63], v[76:79]
    ds_read_b64_tr_b16 a[38:39], v17 offset:17408
    v_mfma_f32_16x16x32_bf16 v[128:131], a[88:91], a[48:51], v[128:131]
    ds_read_b64_tr_b16 a[24:25], v18 offset:0
    v_mfma_f32_16x16x32_bf16 v[132:135], a[88:91], a[52:55], v[132:135]
    ds_read_b64_tr_b16 a[26:27], v18 offset:1024
    v_mfma_f32_16x16x32_bf16 v[136:139], a[88:91], a[56:59], v[136:139]
    ds_read_b64_tr_b16 a[40:41], v18 offset:16384
    v_mfma_f32_16x16x32_bf16 v[140:143], a[88:91], a[60:63], v[140:143]
    ds_read_b64_tr_b16 a[42:43], v18 offset:17408
    s_waitcnt lgkmcnt(15)
    v_mfma_f32_16x16x32_bf16 v[80:83], a[76:79], a[48:51], v[80:83]
    ds_read_b64_tr_b16 a[28:29], v19 offset:0
    v_mfma_f32_16x16x32_bf16 v[84:87], a[76:79], a[52:55], v[84:87]
    ds_read_b64_tr_b16 a[30:31], v19 offset:1024
    v_mfma_f32_16x16x32_bf16 v[88:91], a[76:79], a[56:59], v[88:91]
    ds_read_b64_tr_b16 a[44:45], v19 offset:16384
    v_mfma_f32_16x16x32_bf16 v[92:95], a[76:79], a[60:63], v[92:95]
    ds_read_b64_tr_b16 a[46:47], v19 offset:17408
    s_waitcnt lgkmcnt(15)
    v_mfma_f32_16x16x32_bf16 v[144:147], a[92:95], a[48:51], v[144:147]
    v_mfma_f32_16x16x32_bf16 v[148:151], a[92:95], a[52:55], v[148:151]
    v_mfma_f32_16x16x32_bf16 v[152:155], a[92:95], a[56:59], v[152:155]
    v_mfma_f32_16x16x32_bf16 v[156:159], a[92:95], a[60:63], v[156:159]
    v_mfma_f32_16x16x32_bf16 v[32:35], a[16:19], a[0:3], v[32:35]
    ds_read_b64_tr_b16 a[64:65], v16 offset:8192
    s_waitcnt lgkmcnt(15)
    v_mfma_f32_16x16x32_bf16 v[36:39], a[16:19], a[4:7], v[36:39]
    ds_read_b64_tr_b16 a[66:67], v16 offset:9216
    s_waitcnt lgkmcnt(15)
    v_mfma_f32_16x16x32_bf16 v[40:43], a[16:19], a[8:11], v[40:43]
    ds_read_b128 a[48:51], v15 offset:0
    s_waitcnt lgkmcnt(15)
    v_mfma_f32_16x16x32_bf16 v[44:47], a[16:19], a[12:15], v[44:47]
    ds_read_b128 a[52:55], v15 offset:2048
    s_waitcnt lgkmcnt(15)
    v_mfma_f32_16x16x32_bf16 v[96:99], a[32:35], a[0:3], v[96:99]
    ds_read_b128 a[56:59], v15 offset:4096
    v_mfma_f32_16x16x32_bf16 v[100:103], a[32:35], a[4:7], v[100:103]
    ds_read_b128 a[60:63], v15 offset:6144
    v_mfma_f32_16x16x32_bf16 v[104:107], a[32:35], a[8:11], v[104:107]
    ds_read_b64_tr_b16 a[80:81], v16 offset:24576
    v_mfma_f32_16x16x32_bf16 v[108:111], a[32:35], a[12:15], v[108:111]
    ds_read_b64_tr_b16 a[82:83], v16 offset:25600
    s_waitcnt lgkmcnt(15)
    v_mfma_f32_16x16x32_bf16 v[48:51], a[20:23], a[0:3], v[48:51]
    ds_read_b64_tr_b16 a[68:69], v17 offset:8192
    v_mfma_f32_16x16x32_bf16 v[52:55], a[20:23], a[4:7], v[52:55]
    ds_read_b64_tr_b16 a[70:71], v17 offset:9216
    v_mfma_f32_16x16x32_bf16 v[56:59], a[20:23], a[8:11], v[56:59]
    ds_read_b64_tr_b16 a[84:85], v17 offset:24576
    v_mfma_f32_16x16x32_bf16 v[60:63], a[20:23], a[12:15], v[60:63]
    ds_read_b64_tr_b16 a[86:87], v17 offset:25600
    s_waitcnt lgkmcnt(15)
    v_mfma_f32_16x16x32_bf16 v[112:115], a[36:39], a[0:3], v[112:115]
    ds_read_b64_tr_b16 a[72:73], v18 offset:8192
    v_mfma_f32_16x16x32_bf16 v[116:119], a[36:39], a[4:7], v[116:119]
    ds_read_b64_tr_b16 a[74:75], v18 offset:9216
    v_mfma_f32_16x16x32_bf16 v[120:123], a[36:39], a[8:11], v[120:123]
    ds_read_b64_tr_b16 a[88:89], v18 offset:24576
    v_mfma_f32_16x16x32_bf16 v[124:127], a[36:39], a[12:15], v[124:127]
    ds_read_b64_tr_b16 a[90:91], v18 offset:25600
    s_waitcnt lgkmcnt(15)
    v_mfma_f32_16x16x32_bf16 v[64:67], a[24:27], a[0:3], v[64:67]
    ds_read_b64_tr_b16 a[76:77], v19 offset:8192
    v_mfma_f32_16x16x32_bf16 v[68:71], a[24:27], a[4:7], v[68:71]
    ds_read_b64_tr_b16 a[78:79], v19 offset:9216
    v_mfma_f32_16x16x32_bf16 v[72:75], a[24:27], a[8:11], v[72:75]
    ds_read_b64_tr_b16 a[92:93], v19 offset:24576
    v_mfma_f32_16x16x32_bf16 v[76:79], a[24:27], a[12:15], v[76:79]
    ds_read_b64_tr_b16 a[94:95], v19 offset:25600
    s_waitcnt lgkmcnt(15)
    v_mfma_f32_16x16x32_bf16 v[128:131], a[40:43], a[0:3], v[128:131]
    v_mfma_f32_16x16x32_bf16 v[132:135], a[40:43], a[4:7], v[132:135]
    v_mfma_f32_16x16x32_bf16 v[136:139], a[40:43], a[8:11], v[136:139]
    v_mfma_f32_16x16x32_bf16 v[140:143], a[40:43], a[12:15], v[140:143]
    v_mfma_f32_16x16x32_bf16 v[80:83], a[28:31], a[0:3], v[80:83]
    v_mfma_f32_16x16x32_bf16 v[84:87], a[28:31], a[4:7], v[84:87]
    v_mfma_f32_16x16x32_bf16 v[88:91], a[28:31], a[8:11], v[88:91]
    v_mfma_f32_16x16x32_bf16 v[92:95], a[28:31], a[12:15], v[92:95]
    v_mfma_f32_16x16x32_bf16 v[144:147], a[44:47], a[0:3], v[144:147]
    v_mfma_f32_16x16x32_bf16 v[148:151], a[44:47], a[4:7], v[148:151]
    v_mfma_f32_16x16x32_bf16 v[152:155], a[44:47], a[8:11], v[152:155]
    v_mfma_f32_16x16x32_bf16 v[156:159], a[44:47], a[12:15], v[156:159]
    v_mfma_f32_16x16x32_bf16 v[32:35], a[64:67], a[48:51], v[32:35]
    v_mfma_f32_16x16x32_bf16 v[36:39], a[64:67], a[52:55], v[36:39]
    v_mfma_f32_16x16x32_bf16 v[40:43], a[64:67], a[56:59], v[40:43]
    s_waitcnt lgkmcnt(14)
    v_mfma_f32_16x16x32_bf16 v[44:47], a[64:67], a[60:63], v[44:47]
    s_waitcnt lgkmcnt(12)
    v_mfma_f32_16x16x32_bf16 v[96:99], a[80:83], a[48:51], v[96:99]
    v_mfma_f32_16x16x32_bf16 v[100:103], a[80:83], a[52:55], v[100:103]
    v_mfma_f32_16x16x32_bf16 v[104:107], a[80:83], a[56:59], v[104:107]
    v_mfma_f32_16x16x32_bf16 v[108:111], a[80:83], a[60:63], v[108:111]
    s_waitcnt lgkmcnt(0)
    s_barrier
    v_mfma_f32_16x16x32_bf16 v[48:51], a[68:71], a[48:51], v[48:51]
    ds_read_b64_tr_b16 a[16:17], v22 offset:0
    v_mfma_f32_16x16x32_bf16 v[52:55], a[68:71], a[52:55], v[52:55]
    ds_read_b64_tr_b16 a[18:19], v22 offset:1024
    v_mfma_f32_16x16x32_bf16 v[56:59], a[68:71], a[56:59], v[56:59]
    ds_read_b128 a[0:3], v20 offset:0
    v_mfma_f32_16x16x32_bf16 v[60:63], a[68:71], a[60:63], v[60:63]
    ds_read_b128 a[4:7], v20 offset:2048
    v_mfma_f32_16x16x32_bf16 v[112:115], a[84:87], a[48:51], v[112:115]
    ds_read_b128 a[8:11], v20 offset:4096
    v_mfma_f32_16x16x32_bf16 v[116:119], a[84:87], a[52:55], v[116:119]
    ds_read_b128 a[12:15], v20 offset:6144
    v_mfma_f32_16x16x32_bf16 v[120:123], a[84:87], a[56:59], v[120:123]
    ds_read_b64_tr_b16 a[32:33], v22 offset:16384
    v_mfma_f32_16x16x32_bf16 v[124:127], a[84:87], a[60:63], v[124:127]
    ds_read_b64_tr_b16 a[34:35], v22 offset:17408
    v_mfma_f32_16x16x32_bf16 v[64:67], a[72:75], a[48:51], v[64:67]
    ds_read_b64_tr_b16 a[20:21], v23 offset:0
    v_mfma_f32_16x16x32_bf16 v[68:71], a[72:75], a[52:55], v[68:71]
    ds_read_b64_tr_b16 a[22:23], v23 offset:1024
    v_mfma_f32_16x16x32_bf16 v[72:75], a[72:75], a[56:59], v[72:75]
    ds_read_b64_tr_b16 a[36:37], v23 offset:16384
    v_mfma_f32_16x16x32_bf16 v[76:79], a[72:75], a[60:63], v[76:79]
    ds_read_b64_tr_b16 a[38:39], v23 offset:17408
    v_mfma_f32_16x16x32_bf16 v[128:131], a[88:91], a[48:51], v[128:131]
    ds_read_b64_tr_b16 a[24:25], v24 offset:0
    v_mfma_f32_16x16x32_bf16 v[132:135], a[88:91], a[52:55], v[132:135]
    ds_read_b64_tr_b16 a[26:27], v24 offset:1024
    v_mfma_f32_16x16x32_bf16 v[136:139], a[88:91], a[56:59], v[136:139]
    ds_read_b64_tr_b16 a[40:41], v24 offset:16384
    v_mfma_f32_16x16x32_bf16 v[140:143], a[88:91], a[60:63], v[140:143]
    ds_read_b64_tr_b16 a[42:43], v24 offset:17408
    s_waitcnt lgkmcnt(15)
    v_mfma_f32_16x16x32_bf16 v[80:83], a[76:79], a[48:51], v[80:83]
    ds_read_b64_tr_b16 a[28:29], v25 offset:0
    v_mfma_f32_16x16x32_bf16 v[84:87], a[76:79], a[52:55], v[84:87]
    ds_read_b64_tr_b16 a[30:31], v25 offset:1024
    v_mfma_f32_16x16x32_bf16 v[88:91], a[76:79], a[56:59], v[88:91]
    ds_read_b64_tr_b16 a[44:45], v25 offset:16384
    v_mfma_f32_16x16x32_bf16 v[92:95], a[76:79], a[60:63], v[92:95]
    ds_read_b64_tr_b16 a[46:47], v25 offset:17408
    s_waitcnt lgkmcnt(15)
    v_mfma_f32_16x16x32_bf16 v[144:147], a[92:95], a[48:51], v[144:147]
    v_mfma_f32_16x16x32_bf16 v[148:151], a[92:95], a[52:55], v[148:151]
    v_mfma_f32_16x16x32_bf16 v[152:155], a[92:95], a[56:59], v[152:155]
    v_mfma_f32_16x16x32_bf16 v[156:159], a[92:95], a[60:63], v[156:159]
    v_mfma_f32_16x16x32_bf16 v[32:35], a[16:19], a[0:3], v[32:35]
    ds_read_b64_tr_b16 a[64:65], v22 offset:8192
    s_waitcnt lgkmcnt(15)
    v_mfma_f32_16x16x32_bf16 v[36:39], a[16:19], a[4:7], v[36:39]
    ds_read_b64_tr_b16 a[66:67], v22 offset:9216
    s_waitcnt lgkmcnt(15)
    v_mfma_f32_16x16x32_bf16 v[40:43], a[16:19], a[8:11], v[40:43]
    ds_read_b128 a[48:51], v21 offset:0
    s_waitcnt lgkmcnt(15)
    v_mfma_f32_16x16x32_bf16 v[44:47], a[16:19], a[12:15], v[44:47]
    ds_read_b128 a[52:55], v21 offset:2048
    s_waitcnt lgkmcnt(15)
    v_mfma_f32_16x16x32_bf16 v[96:99], a[32:35], a[0:3], v[96:99]
    ds_read_b128 a[56:59], v21 offset:4096
    v_mfma_f32_16x16x32_bf16 v[100:103], a[32:35], a[4:7], v[100:103]
    ds_read_b128 a[60:63], v21 offset:6144
    v_mfma_f32_16x16x32_bf16 v[104:107], a[32:35], a[8:11], v[104:107]
    ds_read_b64_tr_b16 a[80:81], v22 offset:24576
    v_mfma_f32_16x16x32_bf16 v[108:111], a[32:35], a[12:15], v[108:111]
    ds_read_b64_tr_b16 a[82:83], v22 offset:25600
    s_waitcnt lgkmcnt(15)
    v_mfma_f32_16x16x32_bf16 v[48:51], a[20:23], a[0:3], v[48:51]
    ds_read_b64_tr_b16 a[68:69], v23 offset:8192
    v_mfma_f32_16x16x32_bf16 v[52:55], a[20:23], a[4:7], v[52:55]
    ds_read_b64_tr_b16 a[70:71], v23 offset:9216
    v_mfma_f32_16x16x32_bf16 v[56:59], a[20:23], a[8:11], v[56:59]
    ds_read_b64_tr_b16 a[84:85], v23 offset:24576
    v_mfma_f32_16x16x32_bf16 v[60:63], a[20:23], a[12:15], v[60:63]
    ds_read_b64_tr_b16 a[86:87], v23 offset:25600
    s_waitcnt lgkmcnt(15)
    v_mfma_f32_16x16x32_bf16 v[112:115], a[36:39], a[0:3], v[112:115]
    ds_read_b64_tr_b16 a[72:73], v24 offset:8192
    v_mfma_f32_16x16x32_bf16 v[116:119], a[36:39], a[4:7], v[116:119]
    ds_read_b64_tr_b16 a[74:75], v24 offset:9216
    v_mfma_f32_16x16x32_bf16 v[120:123], a[36:39], a[8:11], v[120:123]
    ds_read_b64_tr_b16 a[88:89], v24 offset:24576
    v_mfma_f32_16x16x32_bf16 v[124:127], a[36:39], a[12:15], v[124:127]
    ds_read_b64_tr_b16 a[90:91], v24 offset:25600
    s_waitcnt lgkmcnt(15)
    v_mfma_f32_16x16x32_bf16 v[64:67], a[24:27], a[0:3], v[64:67]
    ds_read_b64_tr_b16 a[76:77], v25 offset:8192
    v_mfma_f32_16x16x32_bf16 v[68:71], a[24:27], a[4:7], v[68:71]
    ds_read_b64_tr_b16 a[78:79], v25 offset:9216
    v_mfma_f32_16x16x32_bf16 v[72:75], a[24:27], a[8:11], v[72:75]
    ds_read_b64_tr_b16 a[92:93], v25 offset:24576
    v_mfma_f32_16x16x32_bf16 v[76:79], a[24:27], a[12:15], v[76:79]
    ds_read_b64_tr_b16 a[94:95], v25 offset:25600
    s_waitcnt lgkmcnt(15)
    v_mfma_f32_16x16x32_bf16 v[128:131], a[40:43], a[0:3], v[128:131]
    v_mfma_f32_16x16x32_bf16 v[132:135], a[40:43], a[4:7], v[132:135]
    v_mfma_f32_16x16x32_bf16 v[136:139], a[40:43], a[8:11], v[136:139]
    v_mfma_f32_16x16x32_bf16 v[140:143], a[40:43], a[12:15], v[140:143]
    v_mfma_f32_16x16x32_bf16 v[80:83], a[28:31], a[0:3], v[80:83]
    v_mfma_f32_16x16x32_bf16 v[84:87], a[28:31], a[4:7], v[84:87]
    v_mfma_f32_16x16x32_bf16 v[88:91], a[28:31], a[8:11], v[88:91]
    v_mfma_f32_16x16x32_bf16 v[92:95], a[28:31], a[12:15], v[92:95]
    v_mfma_f32_16x16x32_bf16 v[144:147], a[44:47], a[0:3], v[144:147]
    v_mfma_f32_16x16x32_bf16 v[148:151], a[44:47], a[4:7], v[148:151]
    v_mfma_f32_16x16x32_bf16 v[152:155], a[44:47], a[8:11], v[152:155]
    v_mfma_f32_16x16x32_bf16 v[156:159], a[44:47], a[12:15], v[156:159]
    v_mfma_f32_16x16x32_bf16 v[32:35], a[64:67], a[48:51], v[32:35]
    v_mfma_f32_16x16x32_bf16 v[36:39], a[64:67], a[52:55], v[36:39]
    v_mfma_f32_16x16x32_bf16 v[40:43], a[64:67], a[56:59], v[40:43]
    s_waitcnt lgkmcnt(14)
    v_mfma_f32_16x16x32_bf16 v[44:47], a[64:67], a[60:63], v[44:47]
    s_waitcnt lgkmcnt(12)
    v_mfma_f32_16x16x32_bf16 v[96:99], a[80:83], a[48:51], v[96:99]
    v_mfma_f32_16x16x32_bf16 v[100:103], a[80:83], a[52:55], v[100:103]
    v_mfma_f32_16x16x32_bf16 v[104:107], a[80:83], a[56:59], v[104:107]
    v_mfma_f32_16x16x32_bf16 v[108:111], a[80:83], a[60:63], v[108:111]
    s_waitcnt lgkmcnt(0)
    s_barrier
    v_mfma_f32_16x16x32_bf16 v[48:51], a[68:71], a[48:51], v[48:51]
    ds_read_b64_tr_b16 a[16:17], v10 offset:0
    v_mfma_f32_16x16x32_bf16 v[52:55], a[68:71], a[52:55], v[52:55]
    ds_read_b64_tr_b16 a[18:19], v10 offset:1024
    v_mfma_f32_16x16x32_bf16 v[56:59], a[68:71], a[56:59], v[56:59]
    ds_read_b128 a[0:3], v8 offset:0
    v_mfma_f32_16x16x32_bf16 v[60:63], a[68:71], a[60:63], v[60:63]
    ds_read_b128 a[4:7], v8 offset:2048
    v_mfma_f32_16x16x32_bf16 v[112:115], a[84:87], a[48:51], v[112:115]
    ds_read_b128 a[8:11], v8 offset:4096
    v_mfma_f32_16x16x32_bf16 v[116:119], a[84:87], a[52:55], v[116:119]
    ds_read_b128 a[12:15], v8 offset:6144
    v_mfma_f32_16x16x32_bf16 v[120:123], a[84:87], a[56:59], v[120:123]
    ds_read_b64_tr_b16 a[32:33], v10 offset:16384
    v_mfma_f32_16x16x32_bf16 v[124:127], a[84:87], a[60:63], v[124:127]
    ds_read_b64_tr_b16 a[34:35], v10 offset:17408
    v_mfma_f32_16x16x32_bf16 v[64:67], a[72:75], a[48:51], v[64:67]
    ds_read_b64_tr_b16 a[20:21], v11 offset:0
    v_mfma_f32_16x16x32_bf16 v[68:71], a[72:75], a[52:55], v[68:71]
    ds_read_b64_tr_b16 a[22:23], v11 offset:1024
    v_mfma_f32_16x16x32_bf16 v[72:75], a[72:75], a[56:59], v[72:75]
    ds_read_b64_tr_b16 a[36:37], v11 offset:16384
    v_mfma_f32_16x16x32_bf16 v[76:79], a[72:75], a[60:63], v[76:79]
    ds_read_b64_tr_b16 a[38:39], v11 offset:17408
    v_mfma_f32_16x16x32_bf16 v[128:131], a[88:91], a[48:51], v[128:131]
    ds_read_b64_tr_b16 a[24:25], v12 offset:0
    v_mfma_f32_16x16x32_bf16 v[132:135], a[88:91], a[52:55], v[132:135]
    ds_read_b64_tr_b16 a[26:27], v12 offset:1024
    v_mfma_f32_16x16x32_bf16 v[136:139], a[88:91], a[56:59], v[136:139]
    ds_read_b64_tr_b16 a[40:41], v12 offset:16384
    v_mfma_f32_16x16x32_bf16 v[140:143], a[88:91], a[60:63], v[140:143]
    ds_read_b64_tr_b16 a[42:43], v12 offset:17408
    s_waitcnt lgkmcnt(15)
    v_mfma_f32_16x16x32_bf16 v[80:83], a[76:79], a[48:51], v[80:83]
    ds_read_b64_tr_b16 a[28:29], v13 offset:0
    v_mfma_f32_16x16x32_bf16 v[84:87], a[76:79], a[52:55], v[84:87]
    ds_read_b64_tr_b16 a[30:31], v13 offset:1024
    v_mfma_f32_16x16x32_bf16 v[88:91], a[76:79], a[56:59], v[88:91]
    ds_read_b64_tr_b16 a[44:45], v13 offset:16384
    v_mfma_f32_16x16x32_bf16 v[92:95], a[76:79], a[60:63], v[92:95]
    ds_read_b64_tr_b16 a[46:47], v13 offset:17408
    s_waitcnt lgkmcnt(15)
    v_mfma_f32_16x16x32_bf16 v[144:147], a[92:95], a[48:51], v[144:147]
    v_mfma_f32_16x16x32_bf16 v[148:151], a[92:95], a[52:55], v[148:151]
    v_mfma_f32_16x16x32_bf16 v[152:155], a[92:95], a[56:59], v[152:155]
    v_mfma_f32_16x16x32_bf16 v[156:159], a[92:95], a[60:63], v[156:159]
    v_mfma_f32_16x16x32_bf16 v[32:35], a[16:19], a[0:3], v[32:35]
    ds_read_b64_tr_b16 a[64:65], v10 offset:8192
    s_waitcnt lgkmcnt(15)
    v_mfma_f32_16x16x32_bf16 v[36:39], a[16:19], a[4:7], v[36:39]
    ds_read_b64_tr_b16 a[66:67], v10 offset:9216
    s_waitcnt lgkmcnt(15)
    v_mfma_f32_16x16x32_bf16 v[40:43], a[16:19], a[8:11], v[40:43]
    ds_read_b128 a[48:51], v9 offset:0
    s_waitcnt lgkmcnt(15)
    v_mfma_f32_16x16x32_bf16 v[44:47], a[16:19], a[12:15], v[44:47]
    ds_read_b128 a[52:55], v9 offset:2048
    s_waitcnt lgkmcnt(15)
    v_mfma_f32_16x16x32_bf16 v[96:99], a[32:35], a[0:3], v[96:99]
    ds_read_b128 a[56:59], v9 offset:4096
    v_mfma_f32_16x16x32_bf16 v[100:103], a[32:35], a[4:7], v[100:103]
    ds_read_b128 a[60:63], v9 offset:6144
    v_mfma_f32_16x16x32_bf16 v[104:107], a[32:35], a[8:11], v[104:107]
    ds_read_b64_tr_b16 a[80:81], v10 offset:24576
    v_mfma_f32_16x16x32_bf16 v[108:111], a[32:35], a[12:15], v[108:111]
    ds_read_b64_tr_b16 a[82:83], v10 offset:25600
    s_waitcnt lgkmcnt(15)
    v_mfma_f32_16x16x32_bf16 v[48:51], a[20:23], a[0:3], v[48:51]
    ds_read_b64_tr_b16 a[68:69], v11 offset:8192
    v_mfma_f32_16x16x32_bf16 v[52:55], a[20:23], a[4:7], v[52:55]
    ds_read_b64_tr_b16 a[70:71], v11 offset:9216
    v_mfma_f32_16x16x32_bf16 v[56:59], a[20:23], a[8:11], v[56:59]
    ds_read_b64_tr_b16 a[84:85], v11 offset:24576
    v_mfma_f32_16x16x32_bf16 v[60:63], a[20:23], a[12:15], v[60:63]
    ds_read_b64_tr_b16 a[86:87], v11 offset:25600
    s_waitcnt lgkmcnt(15)
    v_mfma_f32_16x16x32_bf16 v[112:115], a[36:39], a[0:3], v[112:115]
    ds_read_b64_tr_b16 a[72:73], v12 offset:8192
    v_mfma_f32_16x16x32_bf16 v[116:119], a[36:39], a[4:7], v[116:119]
    ds_read_b64_tr_b16 a[74:75], v12 offset:9216
    v_mfma_f32_16x16x32_bf16 v[120:123], a[36:39], a[8:11], v[120:123]
    ds_read_b64_tr_b16 a[88:89], v12 offset:24576
    v_mfma_f32_16x16x32_bf16 v[124:127], a[36:39], a[12:15], v[124:127]
    ds_read_b64_tr_b16 a[90:91], v12 offset:25600
    s_waitcnt lgkmcnt(15)
    v_mfma_f32_16x16x32_bf16 v[64:67], a[24:27], a[0:3], v[64:67]
    ds_read_b64_tr_b16 a[76:77], v13 offset:8192
    v_mfma_f32_16x16x32_bf16 v[68:71], a[24:27], a[4:7], v[68:71]
    ds_read_b64_tr_b16 a[78:79], v13 offset:9216
    v_mfma_f32_16x16x32_bf16 v[72:75], a[24:27], a[8:11], v[72:75]
    ds_read_b64_tr_b16 a[92:93], v13 offset:24576
    v_mfma_f32_16x16x32_bf16 v[76:79], a[24:27], a[12:15], v[76:79]
    ds_read_b64_tr_b16 a[94:95], v13 offset:25600
    s_waitcnt lgkmcnt(15)
    v_mfma_f32_16x16x32_bf16 v[128:131], a[40:43], a[0:3], v[128:131]
    v_mfma_f32_16x16x32_bf16 v[132:135], a[40:43], a[4:7], v[132:135]
    v_mfma_f32_16x16x32_bf16 v[136:139], a[40:43], a[8:11], v[136:139]
    v_mfma_f32_16x16x32_bf16 v[140:143], a[40:43], a[12:15], v[140:143]
    v_mfma_f32_16x16x32_bf16 v[80:83], a[28:31], a[0:3], v[80:83]
    v_mfma_f32_16x16x32_bf16 v[84:87], a[28:31], a[4:7], v[84:87]
    v_mfma_f32_16x16x32_bf16 v[88:91], a[28:31], a[8:11], v[88:91]
    v_mfma_f32_16x16x32_bf16 v[92:95], a[28:31], a[12:15], v[92:95]
    v_mfma_f32_16x16x32_bf16 v[144:147], a[44:47], a[0:3], v[144:147]
    v_mfma_f32_16x16x32_bf16 v[148:151], a[44:47], a[4:7], v[148:151]
    v_mfma_f32_16x16x32_bf16 v[152:155], a[44:47], a[8:11], v[152:155]
    v_mfma_f32_16x16x32_bf16 v[156:159], a[44:47], a[12:15], v[156:159]
    v_mfma_f32_16x16x32_bf16 v[32:35], a[64:67], a[48:51], v[32:35]
    v_mfma_f32_16x16x32_bf16 v[36:39], a[64:67], a[52:55], v[36:39]
    v_mfma_f32_16x16x32_bf16 v[40:43], a[64:67], a[56:59], v[40:43]
    s_waitcnt lgkmcnt(14)
    v_mfma_f32_16x16x32_bf16 v[44:47], a[64:67], a[60:63], v[44:47]
    s_waitcnt lgkmcnt(12)
    v_mfma_f32_16x16x32_bf16 v[96:99], a[80:83], a[48:51], v[96:99]
    v_mfma_f32_16x16x32_bf16 v[100:103], a[80:83], a[52:55], v[100:103]
    v_mfma_f32_16x16x32_bf16 v[104:107], a[80:83], a[56:59], v[104:107]
    v_mfma_f32_16x16x32_bf16 v[108:111], a[80:83], a[60:63], v[108:111]
    s_waitcnt lgkmcnt(0)
    s_barrier
    v_mfma_f32_16x16x32_bf16 v[48:51], a[68:71], a[48:51], v[48:51]
    ds_read_b64_tr_b16 a[16:17], v16 offset:0
    v_mfma_f32_16x16x32_bf16 v[52:55], a[68:71], a[52:55], v[52:55]
    ds_read_b64_tr_b16 a[18:19], v16 offset:1024
    v_mfma_f32_16x16x32_bf16 v[56:59], a[68:71], a[56:59], v[56:59]
    ds_read_b128 a[0:3], v14 offset:0
    v_mfma_f32_16x16x32_bf16 v[60:63], a[68:71], a[60:63], v[60:63]
    ds_read_b128 a[4:7], v14 offset:2048
    v_mfma_f32_16x16x32_bf16 v[112:115], a[84:87], a[48:51], v[112:115]
    ds_read_b128 a[8:11], v14 offset:4096
    v_mfma_f32_16x16x32_bf16 v[116:119], a[84:87], a[52:55], v[116:119]
    ds_read_b128 a[12:15], v14 offset:6144
    v_mfma_f32_16x16x32_bf16 v[120:123], a[84:87], a[56:59], v[120:123]
    ds_read_b64_tr_b16 a[32:33], v16 offset:16384
    v_mfma_f32_16x16x32_bf16 v[124:127], a[84:87], a[60:63], v[124:127]
    ds_read_b64_tr_b16 a[34:35], v16 offset:17408
    v_mfma_f32_16x16x32_bf16 v[64:67], a[72:75], a[48:51], v[64:67]
    ds_read_b64_tr_b16 a[20:21], v17 offset:0
    v_mfma_f32_16x16x32_bf16 v[68:71], a[72:75], a[52:55], v[68:71]
    ds_read_b64_tr_b16 a[22:23], v17 offset:1024
    v_mfma_f32_16x16x32_bf16 v[72:75], a[72:75], a[56:59], v[72:75]
    ds_read_b64_tr_b16 a[36:37], v17 offset:16384
    v_mfma_f32_16x16x32_bf16 v[76:79], a[72:75], a[60:63], v[76:79]
    ds_read_b64_tr_b16 a[38:39], v17 offset:17408
    v_mfma_f32_16x16x32_bf16 v[128:131], a[88:91], a[48:51], v[128:131]
    ds_read_b64_tr_b16 a[24:25], v18 offset:0
    v_mfma_f32_16x16x32_bf16 v[132:135], a[88:91], a[52:55], v[132:135]
    ds_read_b64_tr_b16 a[26:27], v18 offset:1024
    v_mfma_f32_16x16x32_bf16 v[136:139], a[88:91], a[56:59], v[136:139]
    ds_read_b64_tr_b16 a[40:41], v18 offset:16384
    v_mfma_f32_16x16x32_bf16 v[140:143], a[88:91], a[60:63], v[140:143]
    ds_read_b64_tr_b16 a[42:43], v18 offset:17408
    s_waitcnt lgkmcnt(15)
    v_mfma_f32_16x16x32_bf16 v[80:83], a[76:79], a[48:51], v[80:83]
    ds_read_b64_tr_b16 a[28:29], v19 offset:0
    v_mfma_f32_16x16x32_bf16 v[84:87], a[76:79], a[52:55], v[84:87]
    ds_read_b64_tr_b16 a[30:31], v19 offset:1024
    v_mfma_f32_16x16x32_bf16 v[88:91], a[76:79], a[56:59], v[88:91]
    ds_read_b64_tr_b16 a[44:45], v19 offset:16384
    v_mfma_f32_16x16x32_bf16 v[92:95], a[76:79], a[60:63], v[92:95]
    ds_read_b64_tr_b16 a[46:47], v19 offset:17408
    s_waitcnt lgkmcnt(15)
    v_mfma_f32_16x16x32_bf16 v[144:147], a[92:95], a[48:51], v[144:147]
    v_mfma_f32_16x16x32_bf16 v[148:151], a[92:95], a[52:55], v[148:151]
    v_mfma_f32_16x16x32_bf16 v[152:155], a[92:95], a[56:59], v[152:155]
    v_mfma_f32_16x16x32_bf16 v[156:159], a[92:95], a[60:63], v[156:159]
    v_mfma_f32_16x16x32_bf16 v[32:35], a[16:19], a[0:3], v[32:35]
    ds_read_b64_tr_b16 a[64:65], v16 offset:8192
    s_waitcnt lgkmcnt(15)
    v_mfma_f32_16x16x32_bf16 v[36:39], a[16:19], a[4:7], v[36:39]
    ds_read_b64_tr_b16 a[66:67], v16 offset:9216
    s_waitcnt lgkmcnt(15)
    v_mfma_f32_16x16x32_bf16 v[40:43], a[16:19], a[8:11], v[40:43]
    ds_read_b128 a[48:51], v15 offset:0
    s_waitcnt lgkmcnt(15)
    v_mfma_f32_16x16x32_bf16 v[44:47], a[16:19], a[12:15], v[44:47]
    ds_read_b128 a[52:55], v15 offset:2048
    s_waitcnt lgkmcnt(15)
    v_mfma_f32_16x16x32_bf16 v[96:99], a[32:35], a[0:3], v[96:99]
    ds_read_b128 a[56:59], v15 offset:4096
    v_mfma_f32_16x16x32_bf16 v[100:103], a[32:35], a[4:7], v[100:103]
    ds_read_b128 a[60:63], v15 offset:6144
    v_mfma_f32_16x16x32_bf16 v[104:107], a[32:35], a[8:11], v[104:107]
    ds_read_b64_tr_b16 a[80:81], v16 offset:24576
    v_mfma_f32_16x16x32_bf16 v[108:111], a[32:35], a[12:15], v[108:111]
    ds_read_b64_tr_b16 a[82:83], v16 offset:25600
    s_waitcnt lgkmcnt(15)
    v_mfma_f32_16x16x32_bf16 v[48:51], a[20:23], a[0:3], v[48:51]
    ds_read_b64_tr_b16 a[68:69], v17 offset:8192
    v_mfma_f32_16x16x32_bf16 v[52:55], a[20:23], a[4:7], v[52:55]
    ds_read_b64_tr_b16 a[70:71], v17 offset:9216
    v_mfma_f32_16x16x32_bf16 v[56:59], a[20:23], a[8:11], v[56:59]
    ds_read_b64_tr_b16 a[84:85], v17 offset:24576
    v_mfma_f32_16x16x32_bf16 v[60:63], a[20:23], a[12:15], v[60:63]
    ds_read_b64_tr_b16 a[86:87], v17 offset:25600
    s_waitcnt lgkmcnt(15)
    v_mfma_f32_16x16x32_bf16 v[112:115], a[36:39], a[0:3], v[112:115]
    ds_read_b64_tr_b16 a[72:73], v18 offset:8192
    v_mfma_f32_16x16x32_bf16 v[116:119], a[36:39], a[4:7], v[116:119]
    ds_read_b64_tr_b16 a[74:75], v18 offset:9216
    v_mfma_f32_16x16x32_bf16 v[120:123], a[36:39], a[8:11], v[120:123]
    ds_read_b64_tr_b16 a[88:89], v18 offset:24576
    v_mfma_f32_16x16x32_bf16 v[124:127], a[36:39], a[12:15], v[124:127]
    ds_read_b64_tr_b16 a[90:91], v18 offset:25600
    s_waitcnt lgkmcnt(15)
    v_mfma_f32_16x16x32_bf16 v[64:67], a[24:27], a[0:3], v[64:67]
    ds_read_b64_tr_b16 a[76:77], v19 offset:8192
    v_mfma_f32_16x16x32_bf16 v[68:71], a[24:27], a[4:7], v[68:71]
    ds_read_b64_tr_b16 a[78:79], v19 offset:9216
    v_mfma_f32_16x16x32_bf16 v[72:75], a[24:27], a[8:11], v[72:75]
    ds_read_b64_tr_b16 a[92:93], v19 offset:24576
    v_mfma_f32_16x16x32_bf16 v[76:79], a[24:27], a[12:15], v[76:79]
    ds_read_b64_tr_b16 a[94:95], v19 offset:25600
    s_waitcnt lgkmcnt(15)
    v_mfma_f32_16x16x32_bf16 v[128:131], a[40:43], a[0:3], v[128:131]
    v_mfma_f32_16x16x32_bf16 v[132:135], a[40:43], a[4:7], v[132:135]
    v_mfma_f32_16x16x32_bf16 v[136:139], a[40:43], a[8:11], v[136:139]
    v_mfma_f32_16x16x32_bf16 v[140:143], a[40:43], a[12:15], v[140:143]
    v_mfma_f32_16x16x32_bf16 v[80:83], a[28:31], a[0:3], v[80:83]
    v_mfma_f32_16x16x32_bf16 v[84:87], a[28:31], a[4:7], v[84:87]
    v_mfma_f32_16x16x32_bf16 v[88:91], a[28:31], a[8:11], v[88:91]
    v_mfma_f32_16x16x32_bf16 v[92:95], a[28:31], a[12:15], v[92:95]
    v_mfma_f32_16x16x32_bf16 v[144:147], a[44:47], a[0:3], v[144:147]
    v_mfma_f32_16x16x32_bf16 v[148:151], a[44:47], a[4:7], v[148:151]
    v_mfma_f32_16x16x32_bf16 v[152:155], a[44:47], a[8:11], v[152:155]
    v_mfma_f32_16x16x32_bf16 v[156:159], a[44:47], a[12:15], v[156:159]
    v_mfma_f32_16x16x32_bf16 v[32:35], a[64:67], a[48:51], v[32:35]
    v_mfma_f32_16x16x32_bf16 v[36:39], a[64:67], a[52:55], v[36:39]
    s_add_u32 s93, s94, 0
    buffer_load_dwordx4 a[0:3], v26, s[68:71], s93 offen sc1
    v_mfma_f32_16x16x32_bf16 v[40:43], a[64:67], a[56:59], v[40:43]
    s_waitcnt lgkmcnt(14)
    v_mfma_f32_16x16x32_bf16 v[44:47], a[64:67], a[60:63], v[44:47]
    buffer_load_dwordx4 a[4:7], v27, s[68:71], s93 offen sc1
    s_waitcnt lgkmcnt(12)
    v_mfma_f32_16x16x32_bf16 v[96:99], a[80:83], a[48:51], v[96:99]
    v_mfma_f32_16x16x32_bf16 v[100:103], a[80:83], a[52:55], v[100:103]
    s_add_u32 s93, s94, 2048
    buffer_load_dwordx4 a[8:11], v26, s[68:71], s93 offen sc1
    v_mfma_f32_16x16x32_bf16 v[104:107], a[80:83], a[56:59], v[104:107]
    v_mfma_f32_16x16x32_bf16 v[108:111], a[80:83], a[60:63], v[108:111]
    buffer_load_dwordx4 a[12:15], v27, s[68:71], s93 offen sc1
    s_waitcnt lgkmcnt(0)
    s_barrier
    v_mfma_f32_16x16x32_bf16 v[48:51], a[68:71], a[48:51], v[48:51]
    v_mfma_f32_16x16x32_bf16 v[52:55], a[68:71], a[52:55], v[52:55]
    s_add_u32 s93, s94, 4096
    buffer_load_dwordx4 a[16:19], v26, s[68:71], s93 offen sc1
    v_mfma_f32_16x16x32_bf16 v[56:59], a[68:71], a[56:59], v[56:59]
    v_mfma_f32_16x16x32_bf16 v[60:63], a[68:71], a[60:63], v[60:63]
    buffer_load_dwordx4 a[20:23], v27, s[68:71], s93 offen sc1
    v_mfma_f32_16x16x32_bf16 v[112:115], a[84:87], a[48:51], v[112:115]
    v_mfma_f32_16x16x32_bf16 v[116:119], a[84:87], a[52:55], v[116:119]
    s_add_u32 s93, s94, 6144
    buffer_load_dwordx4 a[24:27], v26, s[68:71], s93 offen sc1
    v_mfma_f32_16x16x32_bf16 v[120:123], a[84:87], a[56:59], v[120:123]
    v_mfma_f32_16x16x32_bf16 v[124:127], a[84:87], a[60:63], v[124:127]
    buffer_load_dwordx4 a[28:31], v27, s[68:71], s93 offen sc1
    v_mfma_f32_16x16x32_bf16 v[64:67], a[72:75], a[48:51], v[64:67]
    v_mfma_f32_16x16x32_bf16 v[68:71], a[72:75], a[52:55], v[68:71]
    s_add_u32 s93, s94, 8192
    buffer_load_dwordx4 a[32:35], v26, s[68:71], s93 offen sc1
    v_mfma_f32_16x16x32_bf16 v[72:75], a[72:75], a[56:59], v[72:75]
    v_mfma_f32_16x16x32_bf16 v[76:79], a[72:75], a[60:63], v[76:79]
    buffer_load_dwordx4 a[36:39], v27, s[68:71], s93 offen sc1
    v_mfma_f32_16x16x32_bf16 v[128:131], a[88:91], a[48:51], v[128:131]
    v_mfma_f32_16x16x32_bf16 v[132:135], a[88:91], a[52:55], v[132:135]
    s_add_u32 s93, s94, 10240
    buffer_load_dwordx4 a[40:43], v26, s[68:71], s93 offen sc1
    v_mfma_f32_16x16x32_bf16 v[136:139], a[88:91], a[56:59], v[136:139]
    v_mfma_f32_16x16x32_bf16 v[140:143], a[88:91], a[60:63], v[140:143]
    buffer_load_dwordx4 a[44:47], v27, s[68:71], s93 offen sc1
    v_mfma_f32_16x16x32_bf16 v[80:83], a[76:79], a[48:51], v[80:83]
    v_mfma_f32_16x16x32_bf16 v[84:87], a[76:79], a[52:55], v[84:87]
    v_mfma_f32_16x16x32_bf16 v[88:91], a[76:79], a[56:59], v[88:91]
    v_mfma_f32_16x16x32_bf16 v[92:95], a[76:79], a[60:63], v[92:95]
    v_mfma_f32_16x16x32_bf16 v[144:147], a[92:95], a[48:51], v[144:147]
    v_mfma_f32_16x16x32_bf16 v[148:151], a[92:95], a[52:55], v[148:151]
    v_mfma_f32_16x16x32_bf16 v[152:155], a[92:95], a[56:59], v[152:155]
    v_mfma_f32_16x16x32_bf16 v[156:159], a[92:95], a[60:63], v[156:159]
    s_setprio 1
    s_mov_b32 s84, 0xbdd2d3e8
    s_mov_b32 s85, 0xbdd2d3e8
    v_mov_b32 v2, 0xc0135761
    v_mov_b32 v3, 0xc0135761
    v_lshrrev_b32 v4, 4, v0
    v_lshlrev_b32 v4, 9, v4
    v_and_b32 v8, 15, v0
    v_lshlrev_b32 v8, 4, v8
    v_add_u32 v4, v4, v8
    s_lshl_b32 s80, s88, 2
    s_and_b32 s81, s78, 1
    s_lshl_b32 s81, s81, 1
    s_add_u32 s80, s80, s81
    s_mul_i32 s80, s80, 112
    s_lshl_b32 s81, s89, 3
    s_add_u32 s80, s80, s81
    s_lshr_b32 s81, s78, 1
    s_lshl_b32 s81, s81, 2
    s_add_u32 s80, s80, s81
    s_lshl_b32 s80, s80, 10
    s_add_u32 s80, s80, 0x400000
    s_add_u32 s81, s80, 114688
    v_pk_mul_f32 v[8:9], v[32:33], v[32:33]
    v_pk_mul_f32 v[10:11], v[34:35], v[34:35]
    v_pk_mul_f32 v[12:13], v[48:49], v[48:49]
    v_pk_mul_f32 v[14:15], v[50:51], v[50:51]
    v_pk_fma_f32 v[8:9], v[8:9], s[84:85], v[2:3]
    v_pk_fma_f32 v[10:11], v[10:11], s[84:85], v[2:3]
    v_pk_fma_f32 v[12:13], v[12:13], s[84:85], v[2:3]
    v_pk_fma_f32 v[14:15], v[14:15], s[84:85], v[2:3]
    v_pk_mul_f32 v[8:9], v[8:9], v[32:33]
    v_pk_mul_f32 v[10:11], v[10:11], v[34:35]
    v_pk_mul_f32 v[12:13], v[12:13], v[48:49]
    v_pk_mul_f32 v[14:15], v[14:15], v[50:51]
    v_exp_f32 v8, v8
    v_exp_f32 v9, v9
    v_exp_f32 v10, v10
    v_exp_f32 v11, v11
    v_exp_f32 v12, v12
    v_exp_f32 v13, v13
    v_exp_f32 v14, v14
    v_exp_f32 v15, v15
    v_pk_mul_f32 v[32:33], v[32:33], v[96:97]
    v_pk_mul_f32 v[34:35], v[34:35], v[98:99]
    v_pk_mul_f32 v[48:49], v[48:49], v[112:113]
    v_pk_mul_f32 v[50:51], v[50:51], v[114:115]
    v_pk_add_f32 v[8:9], v[8:9], 1.0 op_sel_hi:[1,0]
    v_pk_add_f32 v[10:11], v[10:11], 1.0 op_sel_hi:[1,0]
    v_pk_add_f32 v[12:13], v[12:13], 1.0 op_sel_hi:[1,0]
    v_pk_add_f32 v[14:15], v[14:15], 1.0 op_sel_hi:[1,0]
    v_rcp_f32 v8, v8
    v_rcp_f32 v9, v9
    v_rcp_f32 v10, v10
    v_rcp_f32 v11, v11
    v_rcp_f32 v12, v12
    v_rcp_f32 v13, v13
    v_rcp_f32 v14, v14
    v_rcp_f32 v15, v15
    v_pk_mul_f32 v[32:33], v[32:33], v[8:9]
    v_pk_mul_f32 v[34:35], v[34:35], v[10:11]
    v_pk_mul_f32 v[48:49], v[48:49], v[12:13]
    v_pk_mul_f32 v[50:51], v[50:51], v[14:15]
    v_cvt_pk_bf16_f32 v16, v32, v33
    v_cvt_pk_bf16_f32 v17, v34, v35
    v_cvt_pk_bf16_f32 v18, v48, v49
    v_cvt_pk_bf16_f32 v19, v50, v51
    buffer_store_dwordx4 v[16:19], v4, s[68:71], s80 offen offset:0 sc1
    v_pk_mul_f32 v[8:9], v[36:37], v[36:37]
    v_pk_mul_f32 v[10:11], v[38:39], v[38:39]
    v_pk_mul_f32 v[12:13], v[52:53], v[52:53]
    v_pk_mul_f32 v[14:15], v[54:55], v[54:55]
    v_pk_fma_f32 v[8:9], v[8:9], s[84:85], v[2:3]
    v_pk_fma_f32 v[10:11], v[10:11], s[84:85], v[2:3]
    v_pk_fma_f32 v[12:13], v[12:13], s[84:85], v[2:3]
    v_pk_fma_f32 v[14:15], v[14:15], s[84:85], v[2:3]
    v_pk_mul_f32 v[8:9], v[8:9], v[36:37]
    v_pk_mul_f32 v[10:11], v[10:11], v[38:39]
    v_pk_mul_f32 v[12:13], v[12:13], v[52:53]
    v_pk_mul_f32 v[14:15], v[14:15], v[54:55]
    v_exp_f32 v8, v8
    v_exp_f32 v9, v9
    v_exp_f32 v10, v10
    v_exp_f32 v11, v11
    v_exp_f32 v12, v12
    v_exp_f32 v13, v13
    v_exp_f32 v14, v14
    v_exp_f32 v15, v15
    v_pk_mul_f32 v[36:37], v[36:37], v[100:101]
    v_pk_mul_f32 v[38:39], v[38:39], v[102:103]
    v_pk_mul_f32 v[52:53], v[52:53], v[116:117]
    v_pk_mul_f32 v[54:55], v[54:55], v[118:119]
    v_pk_add_f32 v[8:9], v[8:9], 1.0 op_sel_hi:[1,0]
    v_pk_add_f32 v[10:11], v[10:11], 1.0 op_sel_hi:[1,0]
    v_pk_add_f32 v[12:13], v[12:13], 1.0 op_sel_hi:[1,0]
    v_pk_add_f32 v[14:15], v[14:15], 1.0 op_sel_hi:[1,0]
    v_rcp_f32 v8, v8
    v_rcp_f32 v9, v9
    v_rcp_f32 v10, v10
    v_rcp_f32 v11, v11
    v_rcp_f32 v12, v12
    v_rcp_f32 v13, v13
    v_rcp_f32 v14, v14
    v_rcp_f32 v15, v15
    v_pk_mul_f32 v[36:37], v[36:37], v[8:9]
    v_pk_mul_f32 v[38:39], v[38:39], v[10:11]
    v_pk_mul_f32 v[52:53], v[52:53], v[12:13]
    v_pk_mul_f32 v[54:55], v[54:55], v[14:15]
    v_cvt_pk_bf16_f32 v20, v36, v37
    v_cvt_pk_bf16_f32 v21, v38, v39
    v_cvt_pk_bf16_f32 v22, v52, v53
    v_cvt_pk_bf16_f32 v23, v54, v55
    buffer_store_dwordx4 v[20:23], v4, s[68:71], s80 offen offset:256 sc1
    v_pk_mul_f32 v[8:9], v[40:41], v[40:41]
    v_pk_mul_f32 v[10:11], v[42:43], v[42:43]
    v_pk_mul_f32 v[12:13], v[56:57], v[56:57]
    v_pk_mul_f32 v[14:15], v[58:59], v[58:59]
    v_pk_fma_f32 v[8:9], v[8:9], s[84:85], v[2:3]
    v_pk_fma_f32 v[10:11], v[10:11], s[84:85], v[2:3]
    v_pk_fma_f32 v[12:13], v[12:13], s[84:85], v[2:3]
    v_pk_fma_f32 v[14:15], v[14:15], s[84:85], v[2:3]
    v_pk_mul_f32 v[8:9], v[8:9], v[40:41]
    v_pk_mul_f32 v[10:11], v[10:11], v[42:43]
    v_pk_mul_f32 v[12:13], v[12:13], v[56:57]
    v_pk_mul_f32 v[14:15], v[14:15], v[58:59]
    v_exp_f32 v8, v8
    v_exp_f32 v9, v9
    v_exp_f32 v10, v10
    v_exp_f32 v11, v11
    v_exp_f32 v12, v12
    v_exp_f32 v13, v13
    v_exp_f32 v14, v14
    v_exp_f32 v15, v15
    v_pk_mul_f32 v[40:41], v[40:41], v[104:105]
    v_pk_mul_f32 v[42:43], v[42:43], v[106:107]
    v_pk_mul_f32 v[56:57], v[56:57], v[120:121]
    v_pk_mul_f32 v[58:59], v[58:59], v[122:123]
    v_pk_add_f32 v[8:9], v[8:9], 1.0 op_sel_hi:[1,0]
    v_pk_add_f32 v[10:11], v[10:11], 1.0 op_sel_hi:[1,0]
    v_pk_add_f32 v[12:13], v[12:13], 1.0 op_sel_hi:[1,0]
    v_pk_add_f32 v[14:15], v[14:15], 1.0 op_sel_hi:[1,0]
    v_rcp_f32 v8, v8
    v_rcp_f32 v9, v9
    v_rcp_f32 v10, v10
    v_rcp_f32 v11, v11
    v_rcp_f32 v12, v12
    v_rcp_f32 v13, v13
    v_rcp_f32 v14, v14
    v_rcp_f32 v15, v15
    v_pk_mul_f32 v[40:41], v[40:41], v[8:9]
    v_pk_mul_f32 v[42:43], v[42:43], v[10:11]
    v_pk_mul_f32 v[56:57], v[56:57], v[12:13]
    v_pk_mul_f32 v[58:59], v[58:59], v[14:15]
    v_cvt_pk_bf16_f32 v16, v40, v41
    v_cvt_pk_bf16_f32 v17, v42, v43
    v_cvt_pk_bf16_f32 v18, v56, v57
    v_cvt_pk_bf16_f32 v19, v58, v59
    buffer_store_dwordx4 v[16:19], v4, s[68:71], s81 offen offset:0 sc1
    v_pk_mul_f32 v[8:9], v[44:45], v[44:45]
    v_pk_mul_f32 v[10:11], v[46:47], v[46:47]
    v_pk_mul_f32 v[12:13], v[60:61], v[60:61]
    v_pk_mul_f32 v[14:15], v[62:63], v[62:63]
    v_pk_fma_f32 v[8:9], v[8:9], s[84:85], v[2:3]
    v_pk_fma_f32 v[10:11], v[10:11], s[84:85], v[2:3]
    v_pk_fma_f32 v[12:13], v[12:13], s[84:85], v[2:3]
    v_pk_fma_f32 v[14:15], v[14:15], s[84:85], v[2:3]
    v_pk_mul_f32 v[8:9], v[8:9], v[44:45]
    v_pk_mul_f32 v[10:11], v[10:11], v[46:47]
    v_pk_mul_f32 v[12:13], v[12:13], v[60:61]
    v_pk_mul_f32 v[14:15], v[14:15], v[62:63]
    v_exp_f32 v8, v8
    v_exp_f32 v9, v9
    v_exp_f32 v10, v10
    v_exp_f32 v11, v11
    v_exp_f32 v12, v12
    v_exp_f32 v13, v13
    v_exp_f32 v14, v14
    v_exp_f32 v15, v15
    v_pk_mul_f32 v[44:45], v[44:45], v[108:109]
    v_pk_mul_f32 v[46:47], v[46:47], v[110:111]
    v_pk_mul_f32 v[60:61], v[60:61], v[124:125]
    v_pk_mul_f32 v[62:63], v[62:63], v[126:127]
    v_pk_add_f32 v[8:9], v[8:9], 1.0 op_sel_hi:[1,0]
    v_pk_add_f32 v[10:11], v[10:11], 1.0 op_sel_hi:[1,0]
    v_pk_add_f32 v[12:13], v[12:13], 1.0 op_sel_hi:[1,0]
    v_pk_add_f32 v[14:15], v[14:15], 1.0 op_sel_hi:[1,0]
    v_rcp_f32 v8, v8
    v_rcp_f32 v9, v9
    v_rcp_f32 v10, v10
    v_rcp_f32 v11, v11
    v_rcp_f32 v12, v12
    v_rcp_f32 v13, v13
    v_rcp_f32 v14, v14
    v_rcp_f32 v15, v15
    v_pk_mul_f32 v[44:45], v[44:45], v[8:9]
    v_pk_mul_f32 v[46:47], v[46:47], v[10:11]
    v_pk_mul_f32 v[60:61], v[60:61], v[12:13]
    v_pk_mul_f32 v[62:63], v[62:63], v[14:15]
    v_cvt_pk_bf16_f32 v20, v44, v45
    v_cvt_pk_bf16_f32 v21, v46, v47
    v_cvt_pk_bf16_f32 v22, v60, v61
    v_cvt_pk_bf16_f32 v23, v62, v63
    buffer_store_dwordx4 v[20:23], v4, s[68:71], s81 offen offset:256 sc1
    v_pk_mul_f32 v[8:9], v[64:65], v[64:65]
    v_pk_mul_f32 v[10:11], v[66:67], v[66:67]
    v_pk_mul_f32 v[12:13], v[80:81], v[80:81]
    v_pk_mul_f32 v[14:15], v[82:83], v[82:83]
    v_pk_fma_f32 v[8:9], v[8:9], s[84:85], v[2:3]
    v_pk_fma_f32 v[10:11], v[10:11], s[84:85], v[2:3]
    v_pk_fma_f32 v[12:13], v[12:13], s[84:85], v[2:3]
    v_pk_fma_f32 v[14:15], v[14:15], s[84:85], v[2:3]
    v_pk_mul_f32 v[8:9], v[8:9], v[64:65]
    v_pk_mul_f32 v[10:11], v[10:11], v[66:67]
    v_pk_mul_f32 v[12:13], v[12:13], v[80:81]
    v_pk_mul_f32 v[14:15], v[14:15], v[82:83]
    v_exp_f32 v8, v8
    v_exp_f32 v9, v9
    v_exp_f32 v10, v10
    v_exp_f32 v11, v11
    v_exp_f32 v12, v12
    v_exp_f32 v13, v13
    v_exp_f32 v14, v14
    v_exp_f32 v15, v15
    v_pk_mul_f32 v[64:65], v[64:65], v[128:129]
    v_pk_mul_f32 v[66:67], v[66:67], v[130:131]
    v_pk_mul_f32 v[80:81], v[80:81], v[144:145]
    v_pk_mul_f32 v[82:83], v[82:83], v[146:147]
    v_pk_add_f32 v[8:9], v[8:9], 1.0 op_sel_hi:[1,0]
    v_pk_add_f32 v[10:11], v[10:11], 1.0 op_sel_hi:[1,0]
    v_pk_add_f32 v[12:13], v[12:13], 1.0 op_sel_hi:[1,0]
    v_pk_add_f32 v[14:15], v[14:15], 1.0 op_sel_hi:[1,0]
    v_rcp_f32 v8, v8
    v_rcp_f32 v9, v9
    v_rcp_f32 v10, v10
    v_rcp_f32 v11, v11
    v_rcp_f32 v12, v12
    v_rcp_f32 v13, v13
    v_rcp_f32 v14, v14
    v_rcp_f32 v15, v15
    v_pk_mul_f32 v[64:65], v[64:65], v[8:9]
    v_pk_mul_f32 v[66:67], v[66:67], v[10:11]
    v_pk_mul_f32 v[80:81], v[80:81], v[12:13]
    v_pk_mul_f32 v[82:83], v[82:83], v[14:15]
    v_cvt_pk_bf16_f32 v16, v64, v65
    v_cvt_pk_bf16_f32 v17, v66, v67
    v_cvt_pk_bf16_f32 v18, v80, v81
    v_cvt_pk_bf16_f32 v19, v82, v83
    buffer_store_dwordx4 v[16:19], v4, s[68:71], s80 offen offset:2048 sc1
    v_pk_mul_f32 v[8:9], v[68:69], v[68:69]
    v_pk_mul_f32 v[10:11], v[70:71], v[70:71]
    v_pk_mul_f32 v[12:13], v[84:85], v[84:85]
    v_pk_mul_f32 v[14:15], v[86:87], v[86:87]
    v_pk_fma_f32 v[8:9], v[8:9], s[84:85], v[2:3]
    v_pk_fma_f32 v[10:11], v[10:11], s[84:85], v[2:3]
    v_pk_fma_f32 v[12:13], v[12:13], s[84:85], v[2:3]
    v_pk_fma_f32 v[14:15], v[14:15], s[84:85], v[2:3]
    v_pk_mul_f32 v[8:9], v[8:9], v[68:69]
    v_pk_mul_f32 v[10:11], v[10:11], v[70:71]
    v_pk_mul_f32 v[12:13], v[12:13], v[84:85]
    v_pk_mul_f32 v[14:15], v[14:15], v[86:87]
    v_exp_f32 v8, v8
    v_exp_f32 v9, v9
    v_exp_f32 v10, v10
    v_exp_f32 v11, v11
    v_exp_f32 v12, v12
    v_exp_f32 v13, v13
    v_exp_f32 v14, v14
    v_exp_f32 v15, v15
    v_pk_mul_f32 v[68:69], v[68:69], v[132:133]
    v_pk_mul_f32 v[70:71], v[70:71], v[134:135]
    v_pk_mul_f32 v[84:85], v[84:85], v[148:149]
    v_pk_mul_f32 v[86:87], v[86:87], v[150:151]
    v_pk_add_f32 v[8:9], v[8:9], 1.0 op_sel_hi:[1,0]
    v_pk_add_f32 v[10:11], v[10:11], 1.0 op_sel_hi:[1,0]
    v_pk_add_f32 v[12:13], v[12:13], 1.0 op_sel_hi:[1,0]
    v_pk_add_f32 v[14:15], v[14:15], 1.0 op_sel_hi:[1,0]
    v_rcp_f32 v8, v8
    v_rcp_f32 v9, v9
    v_rcp_f32 v10, v10
    v_rcp_f32 v11, v11
    v_rcp_f32 v12, v12
    v_rcp_f32 v13, v13
    v_rcp_f32 v14, v14
    v_rcp_f32 v15, v15
    v_pk_mul_f32 v[68:69], v[68:69], v[8:9]
    v_pk_mul_f32 v[70:71], v[70:71], v[10:11]
    v_pk_mul_f32 v[84:85], v[84:85], v[12:13]
    v_pk_mul_f32 v[86:87], v[86:87], v[14:15]
    v_cvt_pk_bf16_f32 v20, v68, v69
    v_cvt_pk_bf16_f32 v21, v70, v71
    v_cvt_pk_bf16_f32 v22, v84, v85
    v_cvt_pk_bf16_f32 v23, v86, v87
    buffer_store_dwordx4 v[20:23], v4, s[68:71], s80 offen offset:2304 sc1
    v_pk_mul_f32 v[8:9], v[72:73], v[72:73]
    v_pk_mul_f32 v[10:11], v[74:75], v[74:75]
    v_pk_mul_f32 v[12:13], v[88:89], v[88:89]
    v_pk_mul_f32 v[14:15], v[90:91], v[90:91]
    v_pk_fma_f32 v[8:9], v[8:9], s[84:85], v[2:3]
    v_pk_fma_f32 v[10:11], v[10:11], s[84:85], v[2:3]
    v_pk_fma_f32 v[12:13], v[12:13], s[84:85], v[2:3]
    v_pk_fma_f32 v[14:15], v[14:15], s[84:85], v[2:3]
    v_pk_mul_f32 v[8:9], v[8:9], v[72:73]
    v_pk_mul_f32 v[10:11], v[10:11], v[74:75]
    v_pk_mul_f32 v[12:13], v[12:13], v[88:89]
    v_pk_mul_f32 v[14:15], v[14:15], v[90:91]
    v_exp_f32 v8, v8
    v_exp_f32 v9, v9
    v_exp_f32 v10, v10
    v_exp_f32 v11, v11
    v_exp_f32 v12, v12
    v_exp_f32 v13, v13
    v_exp_f32 v14, v14
    v_exp_f32 v15, v15
    v_pk_mul_f32 v[72:73], v[72:73], v[136:137]
    v_pk_mul_f32 v[74:75], v[74:75], v[138:139]
    v_pk_mul_f32 v[88:89], v[88:89], v[152:153]
    v_pk_mul_f32 v[90:91], v[90:91], v[154:155]
    v_pk_add_f32 v[8:9], v[8:9], 1.0 op_sel_hi:[1,0]
    v_pk_add_f32 v[10:11], v[10:11], 1.0 op_sel_hi:[1,0]
    v_pk_add_f32 v[12:13], v[12:13], 1.0 op_sel_hi:[1,0]
    v_pk_add_f32 v[14:15], v[14:15], 1.0 op_sel_hi:[1,0]
    v_rcp_f32 v8, v8
    v_rcp_f32 v9, v9
    v_rcp_f32 v10, v10
    v_rcp_f32 v11, v11
    v_rcp_f32 v12, v12
    v_rcp_f32 v13, v13
    v_rcp_f32 v14, v14
    v_rcp_f32 v15, v15
    v_pk_mul_f32 v[72:73], v[72:73], v[8:9]
    v_pk_mul_f32 v[74:75], v[74:75], v[10:11]
    v_pk_mul_f32 v[88:89], v[88:89], v[12:13]
    v_pk_mul_f32 v[90:91], v[90:91], v[14:15]
    v_cvt_pk_bf16_f32 v16, v72, v73
    v_cvt_pk_bf16_f32 v17, v74, v75
    v_cvt_pk_bf16_f32 v18, v88, v89
    v_cvt_pk_bf16_f32 v19, v90, v91
    buffer_store_dwordx4 v[16:19], v4, s[68:71], s81 offen offset:2048 sc1
    v_pk_mul_f32 v[8:9], v[76:77], v[76:77]
    v_pk_mul_f32 v[10:11], v[78:79], v[78:79]
    v_pk_mul_f32 v[12:13], v[92:93], v[92:93]
    v_pk_mul_f32 v[14:15], v[94:95], v[94:95]
    v_pk_fma_f32 v[8:9], v[8:9], s[84:85], v[2:3]
    v_pk_fma_f32 v[10:11], v[10:11], s[84:85], v[2:3]
    v_pk_fma_f32 v[12:13], v[12:13], s[84:85], v[2:3]
    v_pk_fma_f32 v[14:15], v[14:15], s[84:85], v[2:3]
    v_pk_mul_f32 v[8:9], v[8:9], v[76:77]
    v_pk_mul_f32 v[10:11], v[10:11], v[78:79]
    v_pk_mul_f32 v[12:13], v[12:13], v[92:93]
    v_pk_mul_f32 v[14:15], v[14:15], v[94:95]
    v_exp_f32 v8, v8
    v_exp_f32 v9, v9
    v_exp_f32 v10, v10
    v_exp_f32 v11, v11
    v_exp_f32 v12, v12
    v_exp_f32 v13, v13
    v_exp_f32 v14, v14
    v_exp_f32 v15, v15
    v_pk_mul_f32 v[76:77], v[76:77], v[140:141]
    v_pk_mul_f32 v[78:79], v[78:79], v[142:143]
    v_pk_mul_f32 v[92:93], v[92:93], v[156:157]
    v_pk_mul_f32 v[94:95], v[94:95], v[158:159]
    v_pk_add_f32 v[8:9], v[8:9], 1.0 op_sel_hi:[1,0]
    v_pk_add_f32 v[10:11], v[10:11], 1.0 op_sel_hi:[1,0]
    v_pk_add_f32 v[12:13], v[12:13], 1.0 op_sel_hi:[1,0]
    v_pk_add_f32 v[14:15], v[14:15], 1.0 op_sel_hi:[1,0]
    v_rcp_f32 v8, v8
    v_rcp_f32 v9, v9
    v_rcp_f32 v10, v10
    v_rcp_f32 v11, v11
    v_rcp_f32 v12, v12
    v_rcp_f32 v13, v13
    v_rcp_f32 v14, v14
    v_rcp_f32 v15, v15
    v_pk_mul_f32 v[76:77], v[76:77], v[8:9]
    v_pk_mul_f32 v[78:79], v[78:79], v[10:11]
    v_pk_mul_f32 v[92:93], v[92:93], v[12:13]
    v_pk_mul_f32 v[94:95], v[94:95], v[14:15]
    v_cvt_pk_bf16_f32 v20, v76, v77
    v_cvt_pk_bf16_f32 v21, v78, v79
    v_cvt_pk_bf16_f32 v22, v92, v93
    v_cvt_pk_bf16_f32 v23, v94, v95
    buffer_store_dwordx4 v[20:23], v4, s[68:71], s81 offen offset:2304 sc1
    v_mov_b32 v24, 1
    ds_write_b32 v30, v24 offset:32
    s_waitcnt vmcnt(0)
    v_mov_b32 v8, s96
    v_mov_b32 v9, 0
    s_mov_b64 exec, 1
    buffer_store_dword v8, v9, s[68:71], s86 offen sc1
    s_mov_b64 exec, -1
    s_branch Lg2
Lnog1:
    s_barrier
    s_sub_u32 s10, s77, 28
    s_lshl_b32 s10, s10, 3
    s_add_u32 s10, s10, s3
    s_mul_i32 s11, s3, 10880
    s_cmp_ge_u32 s3, 3
    s_cselect_b32 s81, 0, 0
    s_add_u32 s11, s11, s81
    s_lshl_b32 s80, s76, 7
    s_add_u32 s8, s42, s80
    s_addc_u32 s9, s43, 0
    s_load_dwordx16 s[16:31], s[8:9], 0
    s_load_dwordx8 s[32:39], s[8:9], 64
    s_load_dwordx8 s[56:63], s[8:9], 96
    v_lshrrev_b32 v5, 3, v0
    v_and_b32 v6, 7, v0
    v_lshlrev_b32 v6, 4, v6
    v_lshlrev_b32 v7, 10, v5
    v_add_u32 v8, v7, v6
    s_lshl_b32 s12, s10, 16
    s_lshl_b32 s81, s76, 7
    s_add_u32 s12, s12, s81
    s_add_u32 m0, s11, 0
    s_add_u32 s13, s12, 0
    buffer_load_dwordx4 v8, s[52:55], s13 offen lds
    s_add_u32 m0, s11, 1056
    s_add_u32 s13, s12, 8192
    buffer_load_dwordx4 v8, s[52:55], s13 offen lds
    s_add_u32 m0, s11, 2112
    s_add_u32 s13, s12, 16384
    buffer_load_dwordx4 v8, s[52:55], s13 offen lds
    s_add_u32 m0, s11, 3168
    s_add_u32 s13, s12, 24576
    buffer_load_dwordx4 v8, s[52:55], s13 offen lds
    s_add_u32 m0, s11, 4224
    s_add_u32 s13, s12, 32768
    buffer_load_dwordx4 v8, s[52:55], s13 offen lds
    s_add_u32 m0, s11, 5280
    s_add_u32 s13, s12, 40960
    buffer_load_dwordx4 v8, s[52:55], s13 offen lds
    s_add_u32 m0, s11, 6336
    s_add_u32 s13, s12, 49152
    buffer_load_dwordx4 v8, s[52:55], s13 offen lds
    s_add_u32 m0, s11, 7392
    s_add_u32 s13, s12, 57344
    buffer_load_dwordx4 v8, s[52:55], s13 offen lds
    v_lshrrev_b32 v5, 3, v0
    v_lshlrev_b32 v5, 10, v5
    v_bfe_u32 v6, v0, 4, 1
    v_lshlrev_b32 v6, 2, v6
    v_and_b32 v7, 7, v0
    v_xor_b32 v6, v6, v7
    v_lshlrev_b32 v6, 4, v6
    v_add_u32 v9, v5, v6
    s_sub_u32 s82, s77, 28
    s_mul_i32 s85, s82, 458752
    s_lshl_b32 s80, s76, 7
    s_add_u32 s85, s85, s80
    s_mul_i32 s83, s78, 3
    s_mov_b32 s86, 0
    s_add_u32 s84, s83, 0
    s_lshr_b32 s80, s84, 1
    s_lshl_b32 s86, s86, 1
    s_add_u32 s80, s80, s86
    s_cmp_ge_u32 s80, 14
    s_cselect_b32 s81, 14, 0
    s_sub_u32 s80, s80, s81
    s_lshl_b32 s80, s80, 15
    s_and_b32 s84, s84, 1
    s_lshl_b32 s84, s84, 13
    s_add_u32 s80, s80, s84
    s_add_u32 s93, s80, s85
    buffer_load_dwordx4 v[128:131], v9, s[64:67], s93 offen
    s_add_u32 s93, s93, 16384
    buffer_load_dwordx4 v[132:135], v9, s[64:67], s93 offen
    s_mov_b32 s86, 0
    s_add_u32 s84, s83, 1
    s_lshr_b32 s80, s84, 1
    s_lshl_b32 s86, s86, 1
    s_add_u32 s80, s80, s86
    s_cmp_ge_u32 s80, 14
    s_cselect_b32 s81, 14, 0
    s_sub_u32 s80, s80, s81
    s_lshl_b32 s80, s80, 15
    s_and_b32 s84, s84, 1
    s_lshl_b32 s84, s84, 13
    s_add_u32 s80, s80, s84
    s_add_u32 s93, s80, s85
    buffer_load_dwordx4 v[136:139], v9, s[64:67], s93 offen
    s_add_u32 s93, s93, 16384
    buffer_load_dwordx4 v[140:143], v9, s[64:67], s93 offen
    s_mov_b32 s86, 0
    s_add_u32 s84, s83, 2
    s_lshr_b32 s80, s84, 1
    s_lshl_b32 s86, s86, 1
    s_add_u32 s80, s80, s86
    s_cmp_ge_u32 s80, 14
    s_cselect_b32 s81, 14, 0
    s_sub_u32 s80, s80, s81
    s_lshl_b32 s80, s80, 15
    s_and_b32 s84, s84, 1
    s_lshl_b32 s84, s84, 13
    s_add_u32 s80, s80, s84
    s_add_u32 s93, s80, s85
    buffer_load_dwordx4 v[144:147], v9, s[64:67], s93 offen
    s_add_u32 s93, s93, 16384
    buffer_load_dwordx4 v[148:151], v9, s[64:67], s93 offen
    v_lshrrev_b32 v5, 3, v0
    v_and_b32 v6, 7, v0
    v_lshlrev_b32 v6, 4, v6
    v_mul_u32_u24 v27, 160, v5
    v_add_u32 v27, v27, v6
    s_add_u32 s12, s11, 9504
    v_add_u32 v27, s12, v27
    v_mul_u32_u24 v5, 4224, v5
    v_add_u32 v30, v5, v6
    v_and_b32 v26, 3, v0
    v_lshrrev_b32 v5, 5, v0
    v_lshlrev_b32 v5, 2, v5
    v_add_u32 v26, v26, v5
    v_mul_u32_u24 v26, 1056, v26
    v_bfe_u32 v5, v0, 2, 2
    v_lshlrev_b32 v6, 7, v5
    v_add_u32 v26, v26, v6
    v_bfe_u32 v6, v0, 4, 1
    v_lshlrev_b32 v6, 3, v6
    v_add_u32 v26, v26, v6
    v_add_u32 v26, s11, v26
    v_bfe_u32 v5, v0, 4, 1
    v_lshlrev_b32 v5, 2, v5
    v_and_b32 v6, 3, v0
    v_add_u32 v5, v5, v6
    v_mul_u32_u24 v5, 160, v5
    v_bfe_u32 v6, v0, 2, 2
    v_lshlrev_b32 v6, 4, v6
    v_add_u32 v5, v5, v6
    v_lshrrev_b32 v6, 5, v0
    v_lshlrev_b32 v6, 6, v6
    v_add_u32 v28, v5, v6
    v_add_u32 v28, s12, v28
    s_mul_i32 s12, s76, 270336
    s_lshl_b32 s81, s10, 7
    s_add_u32 s12, s12, s81
    s_add_u32 s12, s12, 0x1400000
    s_waitcnt lgkmcnt(0)
    v_lshrrev_b32 v5, 3, v0
    v_mul_u32_u24 v5, 1056, v5
    v_and_b32 v6, 7, v0
    v_lshlrev_b32 v6, 7, v6
    v_add_u32 v5, v5, v6
    v_add_u32 v22, s11, v5
    s_waitcnt vmcnt(6)
    ds_read_b64_tr_b16 v[64:65], v26 offset:0
    ds_read_b64_tr_b16 v[66:67], v26 offset:512
    ds_read_b64_tr_b16 v[68:69], v26 offset:16
    ds_read_b64_tr_b16 v[70:71], v26 offset:528
    ds_read_b64_tr_b16 v[72:73], v26 offset:32
    ds_read_b64_tr_b16 v[74:75], v26 offset:544
    s_waitcnt lgkmcnt(4)
    ds_write_b128 v28, v[64:67]
    ds_read_b128 a[0:3], v27
    ds_read_b64_tr_b16 v[76:77], v26 offset:48
    ds_read_b64_tr_b16 v[78:79], v26 offset:560
    s_waitcnt lgkmcnt(6)
    ds_write_b128 v28, v[68:71]
    ds_read_b128 a[4:7], v27
    ds_read_b64_tr_b16 v[80:81], v26 offset:64
    ds_read_b64_tr_b16 v[82:83], v26 offset:576
    s_waitcnt lgkmcnt(8)
    ds_write_b128 v28, v[72:75]
    ds_read_b128 a[8:11], v27
    s_add_u32 s13, s12, 0
    s_waitcnt lgkmcnt(8)
    buffer_store_dwordx4 a[0:3], v30, s[68:71], s13 offen sc1
    ds_read_b64_tr_b16 v[84:85], v26 offset:80
    ds_read_b64_tr_b16 v[86:87], v26 offset:592
    s_waitcnt lgkmcnt(8)
    ds_write_b128 v28, v[76:79]
    ds_read_b128 a[12:15], v27
    s_add_u32 s13, s12, 33792
    s_waitcnt lgkmcnt(8)
    buffer_store_dwordx4 a[4:7], v30, s[68:71], s13 offen sc1
    ds_read_b64_tr_b16 v[88:89], v26 offset:96
    ds_read_b64_tr_b16 v[90:91], v26 offset:608
    s_waitcnt lgkmcnt(8)
    ds_write_b128 v28, v[80:83]
    ds_read_b128 a[16:19], v27
    s_add_u32 s13, s12, 67584
    s_waitcnt lgkmcnt(8)
    buffer_store_dwordx4 a[8:11], v30, s[68:71], s13 offen sc1
    ds_read_b64_tr_b16 v[92:93], v26 offset:112
    ds_read_b64_tr_b16 v[94:95], v26 offset:624
    s_waitcnt lgkmcnt(8)
    ds_write_b128 v28, v[84:87]
    ds_read_b128 a[20:23], v27
    s_add_u32 s13, s12, 101376
    s_waitcnt lgkmcnt(8)
    buffer_store_dwordx4 a[12:15], v30, s[68:71], s13 offen sc1
    s_waitcnt lgkmcnt(6)
    ds_write_b128 v28, v[88:91]
    ds_read_b128 a[24:27], v27
    s_add_u32 s13, s12, 135168
    s_waitcnt lgkmcnt(6)
    buffer_store_dwordx4 a[16:19], v30, s[68:71], s13 offen sc1
    s_waitcnt lgkmcnt(4)
    ds_write_b128 v28, v[92:95]
    ds_read_b128 a[28:31], v27
    s_add_u32 s13, s12, 168960
    s_waitcnt lgkmcnt(4)
    buffer_store_dwordx4 a[20:23], v30, s[68:71], s13 offen sc1
    s_add_u32 s13, s12, 202752
    s_waitcnt lgkmcnt(2)
    buffer_store_dwordx4 a[24:27], v30, s[68:71], s13 offen sc1
    s_add_u32 s13, s12, 236544
    s_waitcnt lgkmcnt(0)
    buffer_store_dwordx4 a[28:31], v30, s[68:71], s13 offen sc1
    ds_read_b128 v[64:67], v22 offset:0
    ds_read_b128 v[68:71], v22 offset:16
    ds_read_b128 v[72:75], v22 offset:32
    ds_read_b128 v[76:79], v22 offset:48
    ds_read_b128 v[80:83], v22 offset:64
    ds_read_b128 v[84:87], v22 offset:80
    ds_read_b128 v[88:91], v22 offset:96
    ds_read_b128 v[92:95], v22 offset:112
    v_mov_b32 v24, 0
    v_mov_b32 v23, 0
    v_mov_b32 v25, s96
    s_waitcnt lgkmcnt(0)
    v_dot2_f32_bf16 v23, v64, s16, v23
    v_dot2_f32_bf16 v24, v65, s17, v24
    v_dot2_f32_bf16 v23, v66, s18, v23
    v_dot2_f32_bf16 v24, v67, s19, v24
    v_dot2_f32_bf16 v23, v68, s20, v23
    v_dot2_f32_bf16 v24, v69, s21, v24
    v_dot2_f32_bf16 v23, v70, s22, v23
    v_dot2_f32_bf16 v24, v71, s23, v24
    v_dot2_f32_bf16 v23, v72, s24, v23
    v_dot2_f32_bf16 v24, v73, s25, v24
    v_dot2_f32_bf16 v23, v74, s26, v23
    v_dot2_f32_bf16 v24, v75, s27, v24
    v_dot2_f32_bf16 v23, v76, s28, v23
    v_dot2_f32_bf16 v24, v77, s29, v24
    v_dot2_f32_bf16 v23, v78, s30, v23
    v_dot2_f32_bf16 v24, v79, s31, v24
    v_dot2_f32_bf16 v23, v80, s32, v23
    v_dot2_f32_bf16 v24, v81, s33, v24
    v_dot2_f32_bf16 v23, v82, s34, v23
    v_dot2_f32_bf16 v24, v83, s35, v24
    v_dot2_f32_bf16 v23, v84, s36, v23
    v_dot2_f32_bf16 v24, v85, s37, v24
    v_dot2_f32_bf16 v23, v86, s38, v23
    v_dot2_f32_bf16 v24, v87, s39, v24
    v_dot2_f32_bf16 v23, v88, s56, v23
    v_dot2_f32_bf16 v24, v89, s57, v24
    v_dot2_f32_bf16 v23, v90, s58, v23
    v_dot2_f32_bf16 v24, v91, s59, v24
    v_dot2_f32_bf16 v23, v92, s60, v23
    v_dot2_f32_bf16 v24, v93, s61, v24
    v_dot2_f32_bf16 v23, v94, s62, v23
    v_dot2_f32_bf16 v24, v95, s63, v24
    s_lshl_b32 s80, s76, 14
    s_lshl_b32 s81, s10, 9
    s_add_u32 s80, s80, s81
    s_add_u32 s80, s80, 0xea0000
    v_lshlrev_b32 v5, 3, v0
    v_add_f32 v24, v23, v24
    buffer_store_dwordx2 v[24:25], v5, s[68:71], s80 offen sc1
    s_lshl_b32 s80, s76, 9
    s_lshr_b32 s81, s10, 3
    s_lshl_b32 s81, s81, 7
    s_add_u32 s80, s80, s81
    s_lshl_b32 s81, s3, 2
    s_add_u32 s80, s80, s81
    s_add_u32 s15, s80, 0xe20000
    v_lshlrev_b32 v9, 4, v0
    v_add_u32 v8, s11, v9
    s_waitcnt vmcnt(14)
    ds_write_b128 v8, v[128:131] offset:0
    s_waitcnt vmcnt(13)
    ds_write_b128 v8, v[132:135] offset:1024
    s_waitcnt vmcnt(12)
    ds_write_b128 v8, v[136:139] offset:2048
    s_waitcnt vmcnt(11)
    ds_write_b128 v8, v[140:143] offset:3072
    s_waitcnt vmcnt(10)
    ds_write_b128 v8, v[144:147] offset:4096
    s_waitcnt vmcnt(9)
    ds_write_b128 v8, v[148:151] offset:5120
    v_lshrrev_b32 v7, 5, v0
    v_lshlrev_b32 v7, 2, v7
    v_bfe_u32 v10, v0, 2, 2
    v_add_u32 v7, v7, v10
    v_lshlrev_b32 v7, 7, v7
    v_bfe_u32 v10, v0, 3, 1
    v_lshlrev_b32 v10, 6, v10
    v_add_u32 v7, v7, v10
    v_bfe_u32 v10, v0, 4, 1
    v_lshlrev_b32 v10, 5, v10
    v_add_u32 v7, v7, v10
    v_and_b32 v10, 3, v0
    v_lshlrev_b32 v10, 3, v10
    v_add_u32 v7, v7, v10
    v_add_u32 v5, s11, v7
    v_xor_b32 v6, 64, v5
    s_sub_u32 s82, s77, 28
    s_lshl_b32 s86, s76, 2
    s_add_u32 s86, s86, s82
    s_lshl_b32 s83, s86, 15
    s_mul_i32 s80, s78, 6144
    s_add_u32 s83, s83, s80
    s_add_u32 s83, s83, 0x1a00000
    ds_read_b64_tr_b16 v[96:97], v5 offset:0
    ds_read_b64_tr_b16 v[98:99], v5 offset:1024
    ds_read_b64_tr_b16 v[100:101], v6 offset:0
    ds_read_b64_tr_b16 v[102:103], v6 offset:1024
    ds_read_b64_tr_b16 v[104:105], v5 offset:2048
    ds_read_b64_tr_b16 v[106:107], v5 offset:3072
    ds_read_b64_tr_b16 v[108:109], v6 offset:2048
    ds_read_b64_tr_b16 v[110:111], v6 offset:3072
    ds_read_b64_tr_b16 v[112:113], v5 offset:4096
    ds_read_b64_tr_b16 v[114:115], v5 offset:5120
    ds_read_b64_tr_b16 v[116:117], v6 offset:4096
    ds_read_b64_tr_b16 v[118:119], v6 offset:5120
    s_waitcnt lgkmcnt(10)
    buffer_store_dwordx4 v[96:99], v9, s[68:71], s83 offen offset:0 sc1
    s_waitcnt lgkmcnt(8)
    buffer_store_dwordx4 v[100:103], v9, s[68:71], s83 offen offset:1024 sc1
    s_add_u32 s83, s83, 2048
    s_waitcnt lgkmcnt(6)
    buffer_store_dwordx4 v[104:107], v9, s[68:71], s83 offen offset:0 sc1
    s_waitcnt lgkmcnt(4)
    buffer_store_dwordx4 v[108:111], v9, s[68:71], s83 offen offset:1024 sc1
    s_add_u32 s83, s83, 2048
    s_waitcnt lgkmcnt(2)
    buffer_store_dwordx4 v[112:115], v9, s[68:71], s83 offen offset:0 sc1
    s_waitcnt lgkmcnt(0)
    buffer_store_dwordx4 v[116:119], v9, s[68:71], s83 offen offset:1024 sc1
    s_lshl_b32 s80, s86, 7
    s_lshl_b32 s81, s78, 2
    s_add_u32 s80, s80, s81
    s_add_u32 s80, s80, 0xe80000
    s_mov_b32 s14, s80
    s_waitcnt vmcnt(0)
    v_mov_b32 v8, s96
    v_mov_b32 v9, 0
    s_mov_b64 exec, 1
    buffer_store_dword v8, v9, s[68:71], s15 offen sc1
    s_mov_b64 exec, -1
    v_mov_b32 v8, s96
    v_mov_b32 v9, 0
    s_mov_b64 exec, 1
    buffer_store_dword v8, v9, s[68:71], s14 offen sc1
    s_mov_b64 exec, -1
    v_lshlrev_b32 v26, 4, v0
    s_lshr_b32 s80, s78, 1
    s_lshl_b32 s80, s80, 10
    v_add_u32 v26, s80, v26
    v_xor_b32 v27, 0x400, v26
    s_lshl_b32 s94, s98, 2
    s_add_u32 s94, s94, s78
    s_lshl_b32 s94, s94, 15
    s_add_u32 s94, s94, 0x1a00000
    s_mov_b32 s18, 0
    s_mov_b32 s19, 1
    s_mov_b32 s20, 2
    s_mov_b32 s21, 3
    s_mov_b32 s22, 4
    s_mov_b32 s23, 5
    s_mov_b32 s24, 6
    s_lshl_b32 s95, s78, 14
    s_add_u32 s95, s95, 32768
    s_lshl_b32 s25, s78, 13
    s_lshl_b32 s80, s88, 1
    s_and_b32 s81, s78, 1
    s_add_u32 s80, s80, s81
    s_lshl_b32 s80, s80, 9
    s_lshl_b32 s81, s89, 1
    s_lshr_b32 s82, s78, 1
    s_add_u32 s81, s81, s82
    s_mul_i32 s82, s81, 37
    s_lshr_b32 s82, s82, 8
    s_mul_i32 s82, s82, 100
    s_lshl_b32 s81, s81, 2
    s_add_u32 s80, s80, s81
    s_add_u32 s80, s80, s82
    s_add_u32 s87, s80, 0xe40000
    s_add_u32 s86, s87, 0x8000
    s_lshl_b32 s80, s78, 2
    s_add_u32 s80, s80, 28944
    v_mov_b32 v30, s80
    v_lshrrev_b32 v7, 5, v0
    v_lshlrev_b32 v7, 2, v7
    v_bfe_u32 v2, v0, 2, 2
    v_add_u32 v7, v7, v2
    v_lshlrev_b32 v7, 7, v7
    v_bfe_u32 v2, v0, 3, 1
    s_lshr_b32 s80, s78, 1
    v_xor_b32 v2, s80, v2
    v_lshlrev_b32 v2, 6, v2
    v_add_u32 v7, v7, v2
    v_bfe_u32 v2, v0, 4, 1
    v_lshlrev_b32 v2, 5, v2
    v_add_u32 v7, v7, v2
    v_and_b32 v2, 3, v0
    v_lshlrev_b32 v2, 3, v2
    v_add_u32 v7, v7, v2
    v_add_u32 v5, s95, v7
    v_xor_b32 v6, 64, v5
    v_add_u32 v28, 0x10000, v5
    v_add_u32 v29, 0x10000, v6
    v_lshlrev_b32 v1, 4, v0
    s_and_b32 s80, s78, 1
    s_mul_i32 s81, s80, 114688
    s_xor_b32 s80, s80, 1
    s_mul_i32 s80, s80, 114688
    v_add_u32 v7, s80, v1
    v_add_u32 v1, s81, v1
    s_mul_i32 s91, s97, 229376
    s_mul_i32 s80, s78, 28672
    s_add_u32 s91, s91, s80
    s_add_u32 s91, s91, 0x400000
    s_lshl_b32 s80, s97, 9
    s_lshl_b32 s81, s78, 7
    s_add_u32 s80, s80, s81
    s_add_u32 s80, s80, 0xe40000
    s_add_u32 s50, s48, s80
    s_addc_u32 s51, s49, 0
    s_barrier
    s_barrier
    v_mov_b32 v9, 1
    ds_write_b32 v30, v9 offset:32
    s_barrier
    s_lshl_b32 s80, s98, 2
    s_add_u32 s80, s80, s78
    s_lshl_b32 s80, s80, 7
    s_add_u32 s80, s80, 0xe80000
    v_and_b32 v8, 3, v0
    v_lshlrev_b32 v8, 2, v8
    s_mov_b32 s99, 0x40000
Lp_2001:
    buffer_load_dword v9, v8, s[68:71], s80 offen sc1
    s_waitcnt vmcnt(0)
    v_cmp_ne_u32 vcc, s96, v9
    s_nop 4
    s_cmp_eq_u64 vcc, 0
    s_cbranch_scc1 Lpd_2002
    s_sleep 8
    s_sub_u32 s99, s99, 1
    s_cmp_lg_u32 s99, 0
    s_cbranch_scc1 Lp_2001
Lpd_2002:
    s_add_u32 s93, s94, 0
    buffer_load_dwordx4 a[0:3], v26, s[68:71], s93 offen sc1
    buffer_load_dwordx4 a[4:7], v27, s[68:71], s93 offen sc1
    s_add_u32 s93, s94, 2048
    buffer_load_dwordx4 a[8:11], v26, s[68:71], s93 offen sc1
    buffer_load_dwordx4 a[12:15], v27, s[68:71], s93 offen sc1
    s_add_u32 s93, s94, 4096
    buffer_load_dwordx4 a[16:19], v26, s[68:71], s93 offen sc1
    buffer_load_dwordx4 a[20:23], v27, s[68:71], s93 offen sc1
    s_add_u32 s93, s94, 6144
    buffer_load_dwordx4 a[24:27], v26, s[68:71], s93 offen sc1
    buffer_load_dwordx4 a[28:31], v27, s[68:71], s93 offen sc1
    s_add_u32 s93, s94, 8192
    buffer_load_dwordx4 a[32:35], v26, s[68:71], s93 offen sc1
    buffer_load_dwordx4 a[36:39], v27, s[68:71], s93 offen sc1
    s_add_u32 s93, s94, 10240
    buffer_load_dwordx4 a[40:43], v26, s[68:71], s93 offen sc1
    buffer_load_dwordx4 a[44:47], v27, s[68:71], s93 offen sc1
    s_add_u32 s93, s94, 12288
    buffer_load_dwordx4 a[48:51], v26, s[68:71], s93 offen sc1
    buffer_load_dwordx4 a[52:55], v27, s[68:71], s93 offen sc1
    s_add_u32 s93, s94, 14336
    buffer_load_dwordx4 a[56:59], v26, s[68:71], s93 offen sc1
    buffer_load_dwordx4 a[60:63], v27, s[68:71], s93 offen sc1
    s_add_u32 s93, s94, 16384
    buffer_load_dwordx4 a[64:67], v26, s[68:71], s93 offen sc1
    buffer_load_dwordx4 a[68:71], v27, s[68:71], s93 offen sc1
    s_add_u32 s93, s94, 18432
    buffer_load_dwordx4 a[72:75], v26, s[68:71], s93 offen sc1
    buffer_load_dwordx4 a[76:79], v27, s[68:71], s93 offen sc1
    s_add_u32 s93, s94, 20480
    buffer_load_dwordx4 a[80:83], v26, s[68:71], s93 offen sc1
    buffer_load_dwordx4 a[84:87], v27, s[68:71], s93 offen sc1
    s_add_u32 s93, s94, 22528
    buffer_load_dwordx4 a[88:91], v26, s[68:71], s93 offen sc1
    buffer_load_dwordx4 a[92:95], v27, s[68:71], s93 offen sc1
    v_mov_b32 v20, v5
    v_mov_b32 v21, v6
    v_mov_b32 v22, v7
    v_lshrrev_b32 v5, 3, v0
    v_lshlrev_b32 v5, 10, v5
    v_bfe_u32 v6, v0, 4, 1
    v_lshlrev_b32 v6, 2, v6
    v_and_b32 v7, 7, v0
    v_xor_b32 v6, v6, v7
    v_lshlrev_b32 v6, 4, v6
    v_add_u32 v23, v5, v6
    s_mul_i32 s94, s78, 458752
    s_lshl_b32 s80, s98, 7
    s_add_u32 s94, s94, s80
    s_add_u32 m0, s95, 0
    s_lshl_b32 s93, s21, 16
    s_add_u32 s93, s93, s94
    buffer_load_dwordx4 v23, s[64:67], s93 offen lds
    s_add_u32 m0, s95, 1024
    s_add_u32 s93, s93, 16384
    buffer_load_dwordx4 v23, s[64:67], s93 offen lds
    s_add_u32 m0, s95, 2048
    s_add_u32 s93, s93, 4294959104
    buffer_load_dwordx4 v23, s[64:67], s93 offen lds
    s_add_u32 m0, s95, 3072
    s_add_u32 s93, s93, 16384
    buffer_load_dwordx4 v23, s[64:67], s93 offen lds
    s_add_u32 m0, s95, 4096
    s_add_u32 s93, s93, 8192
    buffer_load_dwordx4 v23, s[64:67], s93 offen lds
    s_add_u32 m0, s95, 5120
    s_add_u32 s93, s93, 16384
    buffer_load_dwordx4 v23, s[64:67], s93 offen lds
    s_add_u32 m0, s95, 6144
    s_add_u32 s93, s93, 4294959104
    buffer_load_dwordx4 v23, s[64:67], s93 offen lds
    s_add_u32 m0, s95, 7168
    s_add_u32 s93, s93, 16384
    buffer_load_dwordx4 v23, s[64:67], s93 offen lds
    s_add_u32 m0, s95, 8192
    s_lshl_b32 s93, s22, 16
    s_add_u32 s93, s93, s94
    buffer_load_dwordx4 v23, s[64:67], s93 offen lds
    s_add_u32 m0, s95, 9216
    s_add_u32 s93, s93, 16384
    buffer_load_dwordx4 v23, s[64:67], s93 offen lds
    s_add_u32 m0, s95, 10240
    s_add_u32 s93, s93, 4294959104
    buffer_load_dwordx4 v23, s[64:67], s93 offen lds
    s_add_u32 m0, s95, 11264
    s_add_u32 s93, s93, 16384
    buffer_load_dwordx4 v23, s[64:67], s93 offen lds
    s_add_u32 m0, s95, 12288
    s_add_u32 s93, s93, 8192
    buffer_load_dwordx4 v23, s[64:67], s93 offen lds
    s_add_u32 m0, s95, 13312
    s_add_u32 s93, s93, 16384
    buffer_load_dwordx4 v23, s[64:67], s93 offen lds
    s_add_u32 m0, s95, 14336
    s_add_u32 s93, s93, 4294959104
    buffer_load_dwordx4 v23, s[64:67], s93 offen lds
    s_add_u32 m0, s95, 15360
    s_add_u32 s93, s93, 16384
    buffer_load_dwordx4 v23, s[64:67], s93 offen lds
    v_mov_b32 v5, v20
    v_mov_b32 v6, v21
    v_mov_b32 v7, v22
    v_lshlrev_b32 v8, 10, v0
    s_lshl_b32 s80, s23, 16
    s_add_u32 s80, s80, s94
    buffer_load_dword v24, v8, s[64:67], s80 offen
    s_lshl_b32 s80, s24, 16
    s_add_u32 s80, s80, s94
    buffer_load_dword v25, v8, s[64:67], s80 offen
    s_waitcnt vmcnt(0)
Lg2:
    s_setprio 0
    s_cmp_ge_u32 s77, 28
    s_cbranch_scc1 Lsk4
    s_add_u32 s93, s94, 12288
    buffer_load_dwordx4 a[48:51], v26, s[68:71], s93 offen sc1
    buffer_load_dwordx4 a[52:55], v27, s[68:71], s93 offen sc1
    s_add_u32 s93, s94, 14336
    buffer_load_dwordx4 a[56:59], v26, s[68:71], s93 offen sc1
    buffer_load_dwordx4 a[60:63], v27, s[68:71], s93 offen sc1
    s_add_u32 s93, s94, 16384
    buffer_load_dwordx4 a[64:67], v26, s[68:71], s93 offen sc1
    buffer_load_dwordx4 a[68:71], v27, s[68:71], s93 offen sc1
    s_add_u32 s93, s94, 18432
    buffer_load_dwordx4 a[72:75], v26, s[68:71], s93 offen sc1
    buffer_load_dwordx4 a[76:79], v27, s[68:71], s93 offen sc1
    s_add_u32 s93, s94, 20480
    buffer_load_dwordx4 a[80:83], v26, s[68:71], s93 offen sc1
    buffer_load_dwordx4 a[84:87], v27, s[68:71], s93 offen sc1
    s_add_u32 s93, s94, 22528
    buffer_load_dwordx4 a[88:91], v26, s[68:71], s93 offen sc1
    buffer_load_dwordx4 a[92:95], v27, s[68:71], s93 offen sc1
Lsk4:
    s_mov_b32 s99, 0x40000
Ls_2003:
    s_load_dwordx8 s[8:15], s[50:51], 32768 glc
Lsm_2005:
    s_waitcnt lgkmcnt(0)
    s_xor_b32 s8, s8, s96
    s_xor_b32 s9, s9, s96
    s_xor_b32 s10, s10, s96
    s_xor_b32 s11, s11, s96
    s_xor_b32 s12, s12, s96
    s_xor_b32 s13, s13, s96
    s_xor_b32 s14, s14, s96
    s_or_b32 s8, s8, s9
    s_or_b32 s8, s8, s10
    s_or_b32 s8, s8, s11
    s_or_b32 s8, s8, s12
    s_or_b32 s8, s8, s13
    s_or_b32 s8, s8, s14
    s_cbranch_scc0 Lsd_2004
    s_sleep 3
    s_sub_u32 s99, s99, 1
    s_cbranch_scc0 Ls_2003
Lsd_2004:
    s_lshl_b32 s90, s18, 12
    s_add_u32 s90, s90, s91
    buffer_load_dwordx4 v[32:35], v1, s[68:71], s90 offen offset:0 sc1
    buffer_load_dwordx4 v[36:39], v7, s[68:71], s90 offen offset:0 sc1
    buffer_load_dwordx4 v[40:43], v1, s[68:71], s90 offen offset:1024 sc1
    buffer_load_dwordx4 v[44:47], v7, s[68:71], s90 offen offset:1024 sc1
    s_lshl_b32 s90, s18, 12
    s_add_u32 s90, s90, s91
    buffer_load_dwordx4 v[48:51], v1, s[68:71], s90 offen offset:2048 sc1
    buffer_load_dwordx4 v[52:55], v7, s[68:71], s90 offen offset:2048 sc1
    buffer_load_dwordx4 v[56:59], v1, s[68:71], s90 offen offset:3072 sc1
    buffer_load_dwordx4 v[60:63], v7, s[68:71], s90 offen offset:3072 sc1
    s_lshl_b32 s90, s19, 12
    s_add_u32 s90, s90, s91
    buffer_load_dwordx4 v[64:67], v1, s[68:71], s90 offen offset:0 sc1
    buffer_load_dwordx4 v[68:71], v7, s[68:71], s90 offen offset:0 sc1
    buffer_load_dwordx4 v[72:75], v1, s[68:71], s90 offen offset:1024 sc1
    buffer_load_dwordx4 v[76:79], v7, s[68:71], s90 offen offset:1024 sc1
    s_lshl_b32 s90, s19, 12
    s_add_u32 s90, s90, s91
    buffer_load_dwordx4 v[80:83], v1, s[68:71], s90 offen offset:2048 sc1
    buffer_load_dwordx4 v[84:87], v7, s[68:71], s90 offen offset:2048 sc1
    buffer_load_dwordx4 v[88:91], v1, s[68:71], s90 offen offset:3072 sc1
    buffer_load_dwordx4 v[92:95], v7, s[68:71], s90 offen offset:3072 sc1
    s_lshr_b32 s80, s78, 1
    s_mul_i32 s80, s80, 4224
    s_and_b32 s81, s78, 1
    s_lshl_b32 s81, s81, 13
    s_add_u32 s80, s80, s81
    v_lshlrev_b32 v2, 4, v0
    v_xor_b32 v2, s80, v2
    v_add_u32 v2, s95, v2
    s_waitcnt vmcnt(15)
    v_mfma_f32_32x32x16_bf16 v[96:111], a[0:3], v[32:35], 0
    s_waitcnt vmcnt(14)
    v_mfma_f32_32x32x16_bf16 v[112:127], a[0:3], v[36:39], 0
    v_mfma_f32_32x32x16_bf16 v[128:143], a[4:7], v[32:35], 0
    v_mfma_f32_32x32x16_bf16 v[144:159], a[4:7], v[36:39], 0
    s_waitcnt vmcnt(13)
    v_mfma_f32_32x32x16_bf16 v[96:111], a[8:11], v[40:43], v[96:111]
    s_waitcnt vmcnt(12)
    v_mfma_f32_32x32x16_bf16 v[112:127], a[8:11], v[44:47], v[112:127]
    s_lshl_b32 s90, s20, 12
    s_add_u32 s90, s90, s91
    buffer_load_dwordx4 v[32:35], v1, s[68:71], s90 offen offset:0 sc1
    buffer_load_dwordx4 v[36:39], v7, s[68:71], s90 offen offset:0 sc1
    v_mfma_f32_32x32x16_bf16 v[128:143], a[12:15], v[40:43], v[128:143]
    v_mfma_f32_32x32x16_bf16 v[144:159], a[12:15], v[44:47], v[144:159]
    s_waitcnt vmcnt(13)
    v_mfma_f32_32x32x16_bf16 v[96:111], a[16:19], v[48:51], v[96:111]
    s_waitcnt vmcnt(12)
    v_mfma_f32_32x32x16_bf16 v[112:127], a[16:19], v[52:55], v[112:127]
    buffer_load_dwordx4 v[40:43], v1, s[68:71], s90 offen offset:1024 sc1
    buffer_load_dwordx4 v[44:47], v7, s[68:71], s90 offen offset:1024 sc1
    v_mfma_f32_32x32x16_bf16 v[128:143], a[20:23], v[48:51], v[128:143]
    v_mfma_f32_32x32x16_bf16 v[144:159], a[20:23], v[52:55], v[144:159]
    s_waitcnt vmcnt(13)
    v_mfma_f32_32x32x16_bf16 v[96:111], a[24:27], v[56:59], v[96:111]
    s_waitcnt vmcnt(12)
    v_mfma_f32_32x32x16_bf16 v[112:127], a[24:27], v[60:63], v[112:127]
    s_lshl_b32 s90, s20, 12
    s_add_u32 s90, s90, s91
    buffer_load_dwordx4 v[48:51], v1, s[68:71], s90 offen offset:2048 sc1
    buffer_load_dwordx4 v[52:55], v7, s[68:71], s90 offen offset:2048 sc1
    v_mfma_f32_32x32x16_bf16 v[128:143], a[28:31], v[56:59], v[128:143]
    v_mfma_f32_32x32x16_bf16 v[144:159], a[28:31], v[60:63], v[144:159]
    s_waitcnt vmcnt(13)
    v_mfma_f32_32x32x16_bf16 v[96:111], a[32:35], v[64:67], v[96:111]
    s_waitcnt vmcnt(12)
    v_mfma_f32_32x32x16_bf16 v[112:127], a[32:35], v[68:71], v[112:127]
    buffer_load_dwordx4 v[56:59], v1, s[68:71], s90 offen offset:3072 sc1
    buffer_load_dwordx4 v[60:63], v7, s[68:71], s90 offen offset:3072 sc1
    v_mfma_f32_32x32x16_bf16 v[128:143], a[36:39], v[64:67], v[128:143]
    v_mfma_f32_32x32x16_bf16 v[144:159], a[36:39], v[68:71], v[144:159]
    s_waitcnt vmcnt(13)
    v_mfma_f32_32x32x16_bf16 v[96:111], a[40:43], v[72:75], v[96:111]
    s_waitcnt vmcnt(12)
    v_mfma_f32_32x32x16_bf16 v[112:127], a[40:43], v[76:79], v[112:127]
    s_lshl_b32 s90, s21, 12
    s_add_u32 s90, s90, s91
    buffer_load_dwordx4 v[64:67], v1, s[68:71], s90 offen offset:0 sc1
    buffer_load_dwordx4 v[68:71], v7, s[68:71], s90 offen offset:0 sc1
    v_mfma_f32_32x32x16_bf16 v[128:143], a[44:47], v[72:75], v[128:143]
    v_mfma_f32_32x32x16_bf16 v[144:159], a[44:47], v[76:79], v[144:159]
    s_waitcnt vmcnt(13)
    v_mfma_f32_32x32x16_bf16 v[96:111], a[48:51], v[80:83], v[96:111]
    s_waitcnt vmcnt(12)
    v_mfma_f32_32x32x16_bf16 v[112:127], a[48:51], v[84:87], v[112:127]
    buffer_load_dwordx4 v[72:75], v1, s[68:71], s90 offen offset:1024 sc1
    buffer_load_dwordx4 v[76:79], v7, s[68:71], s90 offen offset:1024 sc1
    v_mfma_f32_32x32x16_bf16 v[128:143], a[52:55], v[80:83], v[128:143]
    v_mfma_f32_32x32x16_bf16 v[144:159], a[52:55], v[84:87], v[144:159]
    s_waitcnt vmcnt(13)
    v_mfma_f32_32x32x16_bf16 v[96:111], a[56:59], v[88:91], v[96:111]
    s_waitcnt vmcnt(12)
    v_mfma_f32_32x32x16_bf16 v[112:127], a[56:59], v[92:95], v[112:127]
    s_lshl_b32 s90, s21, 12
    s_add_u32 s90, s90, s91
    buffer_load_dwordx4 v[80:83], v1, s[68:71], s90 offen offset:2048 sc1
    buffer_load_dwordx4 v[84:87], v7, s[68:71], s90 offen offset:2048 sc1
    v_mfma_f32_32x32x16_bf16 v[128:143], a[60:63], v[88:91], v[128:143]
    v_mfma_f32_32x32x16_bf16 v[144:159], a[60:63], v[92:95], v[144:159]
    s_waitcnt vmcnt(13)
    v_mfma_f32_32x32x16_bf16 v[96:111], a[64:67], v[32:35], v[96:111]
    s_waitcnt vmcnt(12)
    v_mfma_f32_32x32x16_bf16 v[112:127], a[64:67], v[36:39], v[112:127]
    buffer_load_dwordx4 v[88:91], v1, s[68:71], s90 offen offset:3072 sc1
    buffer_load_dwordx4 v[92:95], v7, s[68:71], s90 offen offset:3072 sc1
    v_mfma_f32_32x32x16_bf16 v[128:143], a[68:71], v[32:35], v[128:143]
    v_mfma_f32_32x32x16_bf16 v[144:159], a[68:71], v[36:39], v[144:159]
    s_waitcnt vmcnt(13)
    v_mfma_f32_32x32x16_bf16 v[96:111], a[72:75], v[40:43], v[96:111]
    s_waitcnt vmcnt(12)
    v_mfma_f32_32x32x16_bf16 v[112:127], a[72:75], v[44:47], v[112:127]
    s_lshl_b32 s90, s22, 12
    s_add_u32 s90, s90, s91
    buffer_load_dwordx4 v[32:35], v1, s[68:71], s90 offen offset:0 sc1
    buffer_load_dwordx4 v[36:39], v7, s[68:71], s90 offen offset:0 sc1
    v_mfma_f32_32x32x16_bf16 v[128:143], a[76:79], v[40:43], v[128:143]
    v_mfma_f32_32x32x16_bf16 v[144:159], a[76:79], v[44:47], v[144:159]
    s_waitcnt vmcnt(13)
    v_mfma_f32_32x32x16_bf16 v[96:111], a[80:83], v[48:51], v[96:111]
    ds_read_b32 v8, v30 offset:16
    s_waitcnt vmcnt(12)
    v_mfma_f32_32x32x16_bf16 v[112:127], a[80:83], v[52:55], v[112:127]
    buffer_load_dwordx4 v[40:43], v1, s[68:71], s90 offen offset:1024 sc1
    buffer_load_dwordx4 v[44:47], v7, s[68:71], s90 offen offset:1024 sc1
    v_mfma_f32_32x32x16_bf16 v[128:143], a[84:87], v[48:51], v[128:143]
    v_mfma_f32_32x32x16_bf16 v[144:159], a[84:87], v[52:55], v[144:159]
    s_waitcnt vmcnt(13)
    v_mfma_f32_32x32x16_bf16 v[96:111], a[88:91], v[56:59], v[96:111]
    s_waitcnt lgkmcnt(0)
    v_readfirstlane_b32 s80, v8
    s_mov_b32 s99, 0x100000
    s_nop 0
    s_cmp_lg_u32 s80, 0
    s_cbranch_scc1 Lrd_2007
Lr_2006:
    ds_read_b32 v8, v30 offset:16
    s_waitcnt lgkmcnt(0)
    v_readfirstlane_b32 s80, v8
    s_sub_u32 s99, s99, 1
    s_cbranch_scc1 Lrd_2007
    s_cmp_eq_u32 s80, 0
    s_cbranch_scc1 Lr_2006
Lrd_2007:
    ds_read_b64_tr_b16 v[10:11], v5 offset:0
    ds_read_b64_tr_b16 v[12:13], v5 offset:1024
    ds_read_b64_tr_b16 v[14:15], v6 offset:0
    ds_read_b64_tr_b16 v[16:17], v6 offset:1024
    s_waitcnt vmcnt(12)
    v_mfma_f32_32x32x16_bf16 v[112:127], a[88:91], v[60:63], v[112:127]
    s_lshl_b32 s90, s22, 12
    s_add_u32 s90, s90, s91
    buffer_load_dwordx4 v[48:51], v1, s[68:71], s90 offen offset:2048 sc1
    buffer_load_dwordx4 v[52:55], v7, s[68:71], s90 offen offset:2048 sc1
    v_mfma_f32_32x32x16_bf16 v[128:143], a[92:95], v[56:59], v[128:143]
    v_mfma_f32_32x32x16_bf16 v[144:159], a[92:95], v[60:63], v[144:159]
    s_waitcnt vmcnt(13) lgkmcnt(2)
    v_mfma_f32_32x32x16_bf16 v[96:111], v[10:13], v[64:67], v[96:111]
    ds_read_b64_tr_b16 v[18:19], v5 offset:2048
    ds_read_b64_tr_b16 v[20:21], v5 offset:3072
    ds_read_b64_tr_b16 v[22:23], v6 offset:2048
    ds_read_b64_tr_b16 v[24:25], v6 offset:3072
    s_waitcnt vmcnt(12)
    v_mfma_f32_32x32x16_bf16 v[112:127], v[10:13], v[68:71], v[112:127]
    buffer_load_dwordx4 v[56:59], v1, s[68:71], s90 offen offset:3072 sc1
    buffer_load_dwordx4 v[60:63], v7, s[68:71], s90 offen offset:3072 sc1
    s_waitcnt lgkmcnt(4)
    v_mfma_f32_32x32x16_bf16 v[128:143], v[14:17], v[64:67], v[128:143]
    v_mfma_f32_32x32x16_bf16 v[144:159], v[14:17], v[68:71], v[144:159]
    s_waitcnt vmcnt(13) lgkmcnt(2)
    v_mfma_f32_32x32x16_bf16 v[96:111], v[18:21], v[72:75], v[96:111]
    ds_read_b64_tr_b16 v[10:11], v5 offset:4096
    ds_read_b64_tr_b16 v[12:13], v5 offset:5120
    ds_read_b64_tr_b16 v[14:15], v6 offset:4096
    ds_read_b64_tr_b16 v[16:17], v6 offset:5120
    s_waitcnt vmcnt(12)
    v_mfma_f32_32x32x16_bf16 v[112:127], v[18:21], v[76:79], v[112:127]
    s_lshl_b32 s90, s23, 12
    s_add_u32 s90, s90, s91
    buffer_load_dwordx4 v[64:67], v1, s[68:71], s90 offen offset:0 sc1
    buffer_load_dwordx4 v[68:71], v7, s[68:71], s90 offen offset:0 sc1
    s_waitcnt lgkmcnt(4)
    v_mfma_f32_32x32x16_bf16 v[128:143], v[22:25], v[72:75], v[128:143]
    v_mfma_f32_32x32x16_bf16 v[144:159], v[22:25], v[76:79], v[144:159]
    s_waitcnt vmcnt(13) lgkmcnt(2)
    v_mfma_f32_32x32x16_bf16 v[96:111], v[10:13], v[80:83], v[96:111]
    ds_read_b64_tr_b16 v[18:19], v5 offset:6144
    ds_read_b64_tr_b16 v[20:21], v5 offset:7168
    ds_read_b64_tr_b16 v[22:23], v6 offset:6144
    ds_read_b64_tr_b16 v[24:25], v6 offset:7168
    s_waitcnt vmcnt(12)
    v_mfma_f32_32x32x16_bf16 v[112:127], v[10:13], v[84:87], v[112:127]
    buffer_load_dwordx4 v[72:75], v1, s[68:71], s90 offen offset:1024 sc1
    buffer_load_dwordx4 v[76:79], v7, s[68:71], s90 offen offset:1024 sc1
    s_waitcnt lgkmcnt(4)
    v_mfma_f32_32x32x16_bf16 v[128:143], v[14:17], v[80:83], v[128:143]
    v_mfma_f32_32x32x16_bf16 v[144:159], v[14:17], v[84:87], v[144:159]
    s_waitcnt vmcnt(13) lgkmcnt(2)
    v_mfma_f32_32x32x16_bf16 v[96:111], v[18:21], v[88:91], v[96:111]
    ds_read_b64_tr_b16 v[10:11], v5 offset:8192
    ds_read_b64_tr_b16 v[12:13], v5 offset:9216
    ds_read_b64_tr_b16 v[14:15], v6 offset:8192
    ds_read_b64_tr_b16 v[16:17], v6 offset:9216
    s_waitcnt vmcnt(12)
    v_mfma_f32_32x32x16_bf16 v[112:127], v[18:21], v[92:95], v[112:127]
    s_lshl_b32 s90, s23, 12
    s_add_u32 s90, s90, s91
    buffer_load_dwordx4 v[80:83], v1, s[68:71], s90 offen offset:2048 sc1
    buffer_load_dwordx4 v[84:87], v7, s[68:71], s90 offen offset:2048 sc1
    s_waitcnt lgkmcnt(4)
    v_mfma_f32_32x32x16_bf16 v[128:143], v[22:25], v[88:91], v[128:143]
    v_mfma_f32_32x32x16_bf16 v[144:159], v[22:25], v[92:95], v[144:159]
    s_waitcnt vmcnt(13) lgkmcnt(2)
    v_mfma_f32_32x32x16_bf16 v[96:111], v[10:13], v[32:35], v[96:111]
    ds_read_b64_tr_b16 v[18:19], v5 offset:10240
    ds_read_b64_tr_b16 v[20:21], v5 offset:11264
    ds_read_b64_tr_b16 v[22:23], v6 offset:10240
    ds_read_b64_tr_b16 v[24:25], v6 offset:11264
    s_waitcnt vmcnt(12)
    v_mfma_f32_32x32x16_bf16 v[112:127], v[10:13], v[36:39], v[112:127]
    buffer_load_dwordx4 v[88:91], v1, s[68:71], s90 offen offset:3072 sc1
    buffer_load_dwordx4 v[92:95], v7, s[68:71], s90 offen offset:3072 sc1
    s_waitcnt lgkmcnt(4)
    v_mfma_f32_32x32x16_bf16 v[128:143], v[14:17], v[32:35], v[128:143]
    v_mfma_f32_32x32x16_bf16 v[144:159], v[14:17], v[36:39], v[144:159]
    s_waitcnt vmcnt(13) lgkmcnt(2)
    v_mfma_f32_32x32x16_bf16 v[96:111], v[18:21], v[40:43], v[96:111]
    ds_read_b64_tr_b16 v[10:11], v5 offset:12288
    ds_read_b64_tr_b16 v[12:13], v5 offset:13312
    ds_read_b64_tr_b16 v[14:15], v6 offset:12288
    ds_read_b64_tr_b16 v[16:17], v6 offset:13312
    s_waitcnt vmcnt(12)
    v_mfma_f32_32x32x16_bf16 v[112:127], v[18:21], v[44:47], v[112:127]
    s_lshl_b32 s90, s24, 12
    s_add_u32 s90, s90, s91
    buffer_load_dwordx4 v[32:35], v1, s[68:71], s90 offen offset:0 sc1
    buffer_load_dwordx4 v[36:39], v7, s[68:71], s90 offen offset:0 sc1
    s_waitcnt lgkmcnt(4)
    v_mfma_f32_32x32x16_bf16 v[128:143], v[22:25], v[40:43], v[128:143]
    v_mfma_f32_32x32x16_bf16 v[144:159], v[22:25], v[44:47], v[144:159]
    s_waitcnt vmcnt(13) lgkmcnt(2)
    v_mfma_f32_32x32x16_bf16 v[96:111], v[10:13], v[48:51], v[96:111]
    ds_read_b32 v8, v30 offset:0
    ds_read_b64_tr_b16 v[18:19], v5 offset:14336
    ds_read_b64_tr_b16 v[20:21], v5 offset:15360
    ds_read_b64_tr_b16 v[22:23], v6 offset:14336
    ds_read_b64_tr_b16 v[24:25], v6 offset:15360
    s_waitcnt vmcnt(12)
    v_mfma_f32_32x32x16_bf16 v[112:127], v[10:13], v[52:55], v[112:127]
    buffer_load_dwordx4 v[40:43], v1, s[68:71], s90 offen offset:1024 sc1
    buffer_load_dwordx4 v[44:47], v7, s[68:71], s90 offen offset:1024 sc1
    s_waitcnt lgkmcnt(5)
    v_mfma_f32_32x32x16_bf16 v[128:143], v[14:17], v[48:51], v[128:143]
    v_mfma_f32_32x32x16_bf16 v[144:159], v[14:17], v[52:55], v[144:159]
    s_waitcnt vmcnt(13) lgkmcnt(2)
    v_mfma_f32_32x32x16_bf16 v[96:111], v[18:21], v[56:59], v[96:111]
    v_readfirstlane_b32 s80, v8
    s_mov_b32 s99, 0x100000
    s_nop 0
    s_cmp_lg_u32 s80, 0
    s_cbranch_scc1 Lrd_2009
Lr_2008:
    ds_read_b32 v8, v30 offset:0
    s_waitcnt lgkmcnt(0)
    v_readfirstlane_b32 s80, v8
    s_sub_u32 s99, s99, 1
    s_cbranch_scc1 Lrd_2009
    s_cmp_eq_u32 s80, 0
    s_cbranch_scc1 Lr_2008
Lrd_2009:
    ds_read_b64_tr_b16 v[10:11], v28 offset:0
    ds_read_b64_tr_b16 v[12:13], v28 offset:1024
    ds_read_b64_tr_b16 v[14:15], v29 offset:0
    ds_read_b64_tr_b16 v[16:17], v29 offset:1024
    s_waitcnt vmcnt(12)
    v_mfma_f32_32x32x16_bf16 v[112:127], v[18:21], v[60:63], v[112:127]
    s_lshl_b32 s90, s24, 12
    s_add_u32 s90, s90, s91
    buffer_load_dwordx4 v[48:51], v1, s[68:71], s90 offen offset:2048 sc1
    buffer_load_dwordx4 v[52:55], v7, s[68:71], s90 offen offset:2048 sc1
    s_waitcnt lgkmcnt(4)
    v_mfma_f32_32x32x16_bf16 v[128:143], v[22:25], v[56:59], v[128:143]
    v_mfma_f32_32x32x16_bf16 v[144:159], v[22:25], v[60:63], v[144:159]
    s_waitcnt vmcnt(13) lgkmcnt(2)
    v_mfma_f32_32x32x16_bf16 v[96:111], v[10:13], v[64:67], v[96:111]
    ds_read_b64_tr_b16 v[18:19], v28 offset:2048
    ds_read_b64_tr_b16 v[20:21], v28 offset:3072
    ds_read_b64_tr_b16 v[22:23], v29 offset:2048
    ds_read_b64_tr_b16 v[24:25], v29 offset:3072
    s_waitcnt vmcnt(12)
    v_mfma_f32_32x32x16_bf16 v[112:127], v[10:13], v[68:71], v[112:127]
    buffer_load_dwordx4 v[56:59], v1, s[68:71], s90 offen offset:3072 sc1
    buffer_load_dwordx4 v[60:63], v7, s[68:71], s90 offen offset:3072 sc1
    s_waitcnt lgkmcnt(4)
    v_mfma_f32_32x32x16_bf16 v[128:143], v[14:17], v[64:67], v[128:143]
    v_mfma_f32_32x32x16_bf16 v[144:159], v[14:17], v[68:71], v[144:159]
    s_waitcnt vmcnt(13) lgkmcnt(2)
    v_mfma_f32_32x32x16_bf16 v[96:111], v[18:21], v[72:75], v[96:111]
    ds_read_b64_tr_b16 v[10:11], v28 offset:4096
    ds_read_b64_tr_b16 v[12:13], v28 offset:5120
    ds_read_b64_tr_b16 v[14:15], v29 offset:4096
    ds_read_b64_tr_b16 v[16:17], v29 offset:5120
    s_waitcnt vmcnt(12)
    v_mfma_f32_32x32x16_bf16 v[112:127], v[18:21], v[76:79], v[112:127]
    s_waitcnt lgkmcnt(4)
    v_mfma_f32_32x32x16_bf16 v[128:143], v[22:25], v[72:75], v[128:143]
    v_mfma_f32_32x32x16_bf16 v[144:159], v[22:25], v[76:79], v[144:159]
    s_waitcnt vmcnt(11) lgkmcnt(2)
    v_mfma_f32_32x32x16_bf16 v[96:111], v[10:13], v[80:83], v[96:111]
    ds_read_b64_tr_b16 v[18:19], v28 offset:6144
    ds_read_b64_tr_b16 v[20:21], v28 offset:7168
    ds_read_b64_tr_b16 v[22:23], v29 offset:6144
    ds_read_b64_tr_b16 v[24:25], v29 offset:7168
    s_waitcnt vmcnt(10)
    v_mfma_f32_32x32x16_bf16 v[112:127], v[10:13], v[84:87], v[112:127]
    ds_read_b64_tr_b16 a[0:1], v28 offset:8192
    ds_read_b64_tr_b16 a[2:3], v28 offset:9216
    ds_read_b64_tr_b16 a[4:5], v29 offset:8192
    s_waitcnt lgkmcnt(7)
    v_mfma_f32_32x32x16_bf16 v[128:143], v[14:17], v[80:83], v[128:143]
    ds_read_b64_tr_b16 a[6:7], v29 offset:9216
    ds_read_b64_tr_b16 a[8:9], v28 offset:10240
    ds_read_b64_tr_b16 a[10:11], v28 offset:11264
    v_mfma_f32_32x32x16_bf16 v[144:159], v[14:17], v[84:87], v[144:159]
    ds_read_b64_tr_b16 a[12:13], v29 offset:10240
    ds_read_b64_tr_b16 a[14:15], v29 offset:11264
    s_waitcnt vmcnt(9) lgkmcnt(10)
    v_mfma_f32_32x32x16_bf16 v[96:111], v[18:21], v[88:91], v[96:111]
    s_waitcnt vmcnt(8)
    v_mfma_f32_32x32x16_bf16 v[112:127], v[18:21], v[92:95], v[112:127]
    ds_read_b64_tr_b16 a[16:17], v28 offset:12288
    ds_read_b64_tr_b16 a[18:19], v28 offset:13312
    ds_read_b64_tr_b16 a[20:21], v29 offset:12288
    s_waitcnt lgkmcnt(11)
    v_mfma_f32_32x32x16_bf16 v[128:143], v[22:25], v[88:91], v[128:143]
    ds_read_b64_tr_b16 a[22:23], v29 offset:13312
    ds_read_b64_tr_b16 a[24:25], v28 offset:14336
    ds_read_b64_tr_b16 a[26:27], v28 offset:15360
    v_mfma_f32_32x32x16_bf16 v[144:159], v[22:25], v[92:95], v[144:159]
    ds_read_b64_tr_b16 a[28:29], v29 offset:14336
    ds_read_b64_tr_b16 a[30:31], v29 offset:15360
    s_waitcnt vmcnt(7) lgkmcnt(14)
    v_mfma_f32_32x32x16_bf16 v[96:111], a[0:3], v[32:35], v[96:111]
    s_and_b32 s80, s3, 3
    s_lshl_b32 s80, s80, 3
    v_lshrrev_b32 v14, 3, v0
    v_add_u32 v12, s80, v14
    v_lshlrev_b32 v13, 10, v14
    v_and_b32 v14, 7, v0
    s_waitcnt vmcnt(5) lgkmcnt(10)
    v_mfma_f32_32x32x16_bf16 v[96:111], a[8:11], v[40:43], v[96:111]
    v_lshlrev_b32 v10, 4, v14
    v_add_u32 v13, v13, v10
    v_mul_u32_u24 v10, 0x420, v14
    v_lshlrev_b32 v11, 4, v12
    v_xor_b32 v10, v10, v11
    s_lshr_b32 s81, s3, 2
    s_waitcnt vmcnt(3) lgkmcnt(6)
    v_mfma_f32_32x32x16_bf16 v[96:111], a[16:19], v[48:51], v[96:111]
    s_lshl_b32 s80, s81, 13
    s_add_u32 s80, s80, 32768
    v_add_u32 v10, s80, v10
    v_lshlrev_b32 v11, 6, v12
    v_and_b32 v14, 3, v0
    v_lshlrev_b32 v14, 4, v14
    s_waitcnt vmcnt(1) lgkmcnt(2)
    v_mfma_f32_32x32x16_bf16 v[96:111], a[24:27], v[56:59], v[96:111]
    v_add_u32 v11, v11, v14
    v_bfe_u32 v14, v0, 2, 1
    v_lshlrev_b32 v14, 13, v14
    v_add_u32 v11, v11, v14
    s_lshl_b32 s80, s81, 12
    s_add_u32 s80, s80, 0
    v_mfma_f32_32x32x16_bf16 v[112:127], a[0:3], v[36:39], v[112:127]
    v_add_u32 v11, s80, v11
    v_lshlrev_b32 v12, 2, v12
    v_add_u32 v12, s80, v12
    s_lshl_b32 s87, s97, 16
    s_lshl_b32 s81, s3, 13
    s_add_u32 s87, s87, s81
    v_mfma_f32_32x32x16_bf16 v[112:127], a[8:11], v[44:47], v[112:127]
    s_lshl_b32 s81, s98, 7
    s_add_u32 s87, s87, s81
    v_mfma_f32_32x32x16_bf16 v[112:127], a[16:19], v[52:55], v[112:127]
    v_xor_b32 v16, 0x0, v2
    ds_write_b128 v16, v[96:99]
    s_waitcnt vmcnt(0)
    v_mfma_f32_32x32x16_bf16 v[112:127], a[24:27], v[60:63], v[112:127]
    v_xor_b32 v17, 0x420, v2
    ds_write_b128 v17, v[100:103]
    v_mfma_f32_32x32x16_bf16 v[128:143], a[4:7], v[32:35], v[128:143]
    v_xor_b32 v18, 0x840, v2
    ds_write_b128 v18, v[104:107]
    v_mfma_f32_32x32x16_bf16 v[128:143], a[12:15], v[40:43], v[128:143]
    v_xor_b32 v19, 0xc60, v2
    ds_write_b128 v19, v[108:111]
    v_mfma_f32_32x32x16_bf16 v[128:143], a[20:23], v[48:51], v[128:143]
    v_xor_b32 v16, 0x2000, v2
    s_nop 1
    ds_write_b128 v16, v[112:115]
    s_waitcnt lgkmcnt(5)
    v_mfma_f32_32x32x16_bf16 v[128:143], a[28:31], v[56:59], v[128:143]
    v_xor_b32 v17, 0x2420, v2
    ds_write_b128 v17, v[116:119]
    v_mfma_f32_32x32x16_bf16 v[144:159], a[4:7], v[36:39], v[144:159]
    v_xor_b32 v18, 0x2840, v2
    ds_write_b128 v18, v[120:123]
    v_mfma_f32_32x32x16_bf16 v[144:159], a[12:15], v[44:47], v[144:159]
    v_xor_b32 v19, 0x2c60, v2
    ds_write_b128 v19, v[124:127]
    v_mfma_f32_32x32x16_bf16 v[144:159], a[20:23], v[52:55], v[144:159]
    v_xor_b32 v16, 0x1080, v2
    s_nop 1
    ds_write_b128 v16, v[128:131]
    v_mfma_f32_32x32x16_bf16 v[144:159], a[28:31], v[60:63], v[144:159]
    v_xor_b32 v17, 0x14a0, v2
    ds_write_b128 v17, v[132:135]
    v_xor_b32 v18, 0x18c0, v2
    ds_write_b128 v18, v[136:139]
    v_xor_b32 v19, 0x1ce0, v2
    ds_write_b128 v19, v[140:143]
    v_xor_b32 v16, 0x3080, v2
    s_nop 4
    ds_write_b128 v16, v[144:147]
    v_xor_b32 v17, 0x34a0, v2
    ds_write_b128 v17, v[148:151]
    v_xor_b32 v18, 0x38c0, v2
    ds_write_b128 v18, v[152:155]
    v_xor_b32 v19, 0x3ce0, v2
    ds_write_b128 v19, v[156:159]
    s_waitcnt lgkmcnt(0)
    s_barrier
    ds_read_b128 v[64:67], v10 offset:0
    ds_read_b128 v[72:75], v10 offset:16384
    ds_read_b128 v[80:83], v10 offset:32768
    ds_read_b128 v[88:91], v10 offset:49152
    ds_read_b32 v3, v12
    ds_read_b128 v[68:71], v10 offset:512
    ds_read_b128 v[76:79], v10 offset:16896
    ds_read_b128 v[84:87], v10 offset:33280
    ds_read_b128 v[92:95], v10 offset:49664
    ds_read_b128 v[44:47], v11 offset:2048
    s_waitcnt lgkmcnt(8)
    v_pk_add_f32 v[64:65], v[64:65], v[72:73]
    s_waitcnt lgkmcnt(6)
    v_pk_add_f32 v[80:81], v[80:81], v[88:89]
    v_pk_add_f32 v[66:67], v[66:67], v[74:75]
    v_pk_add_f32 v[82:83], v[82:83], v[90:91]
    s_waitcnt lgkmcnt(3)
    v_pk_add_f32 v[68:69], v[68:69], v[76:77]
    s_waitcnt lgkmcnt(1)
    v_pk_add_f32 v[84:85], v[84:85], v[92:93]
    v_pk_add_f32 v[70:71], v[70:71], v[78:79]
    v_pk_add_f32 v[86:87], v[86:87], v[94:95]
    v_pk_add_f32 v[64:65], v[64:65], v[80:81]
    v_pk_add_f32 v[66:67], v[66:67], v[82:83]
    v_pk_add_f32 v[68:69], v[68:69], v[84:85]
    v_pk_add_f32 v[70:71], v[70:71], v[86:87]
    s_waitcnt lgkmcnt(0)
    v_lshlrev_b32 v80, 16, v44
    v_and_b32 v81, 0xffff0000, v44
    v_lshlrev_b32 v82, 16, v45
    v_and_b32 v83, 0xffff0000, v45
    v_lshlrev_b32 v84, 16, v46
    v_and_b32 v85, 0xffff0000, v46
    v_lshlrev_b32 v86, 16, v47
    v_and_b32 v87, 0xffff0000, v47
    v_fmac_f32 v80, v3, v64
    v_fmac_f32 v81, v3, v65
    v_fmac_f32 v82, v3, v66
    v_fmac_f32 v83, v3, v67
    v_fmac_f32 v84, v3, v68
    v_fmac_f32 v85, v3, v69
    v_fmac_f32 v86, v3, v70
    v_fmac_f32 v87, v3, v71
    v_cvt_pk_bf16_f32 v44, v80, v81
    v_cvt_pk_bf16_f32 v45, v82, v83
    v_cvt_pk_bf16_f32 v46, v84, v85
    v_cvt_pk_bf16_f32 v47, v86, v87
    buffer_store_dwordx4 v[44:47], v13, s[72:75], s87 offen sc1
Lend:
    s_endpgm
Lhidle:
    s_mov_b32 s52, s16
    s_and_b32 s53, s17, 0xffff
    s_mov_b32 s54, 0x200000
    s_mov_b32 s55, 0x20000
    s_add_u32 s50, s48, 0xe10000
    s_addc_u32 s51, s49, 0
    s_load_dword s96, s[50:51], 0
    s_mov_b32 s68, s48
    s_and_b32 s69, s49, 0xffff
    s_mov_b32 s70, 0x10000000
    s_mov_b32 s71, 0x20000
    s_mov_b32 s64, s40
    s_and_b32 s65, s41, 0xffff
    s_mov_b32 s66, 0x1c0000
    s_mov_b32 s67, 0x20000
    s_mov_b32 s72, s44
    s_and_b32 s73, s45, 0xffff
    s_mov_b32 s74, 0x200000
    s_mov_b32 s75, 0x20000
    s_lshl_b32 s80, s78, 9
    v_lshlrev_b32 v152, 3, v0
    v_add_u32 v152, s80, v152
    v_add_u32 v153, 7, v152
    v_cvt_f32_u32 v154, v153
    v_cvt_pk_bf16_f32 v154, v154, v154
    v_and_b32 v154, 0xffff, v154
    v_subrev_u32 v154, 0x4280, v154
    v_cmp_gt_u32 vcc, 0x80, v153
    s_nop 1
    v_cndmask_b32 v154, v154, v153, vcc
    v_lshlrev_b32 v154, 1, v154
    v_add_u32 v144, 0x27400, v154
    v_add_u32 v153, 6, v152
    v_cvt_f32_u32 v154, v153
    v_cvt_pk_bf16_f32 v154, v154, v154
    v_and_b32 v154, 0xffff, v154
    v_subrev_u32 v154, 0x4280, v154
    v_cmp_gt_u32 vcc, 0x80, v153
    s_nop 1
    v_cndmask_b32 v154, v154, v153, vcc
    v_lshlrev_b32 v154, 1, v154
    v_add_u32 v145, 0x27400, v154
    v_add_u32 v153, 5, v152
    v_cvt_f32_u32 v154, v153
    v_cvt_pk_bf16_f32 v154, v154, v154
    v_and_b32 v154, 0xffff, v154
    v_subrev_u32 v154, 0x4280, v154
    v_cmp_gt_u32 vcc, 0x80, v153
    s_nop 1
    v_cndmask_b32 v154, v154, v153, vcc
    v_lshlrev_b32 v154, 1, v154
    v_add_u32 v146, 0x27400, v154
    v_add_u32 v153, 4, v152
    v_cvt_f32_u32 v154, v153
    v_cvt_pk_bf16_f32 v154, v154, v154
    v_and_b32 v154, 0xffff, v154
    v_subrev_u32 v154, 0x4280, v154
    v_cmp_gt_u32 vcc, 0x80, v153
    s_nop 1
    v_cndmask_b32 v154, v154, v153, vcc
    v_lshlrev_b32 v154, 1, v154
    v_add_u32 v147, 0x27400, v154
    v_add_u32 v153, 3, v152
    v_cvt_f32_u32 v154, v153
    v_cvt_pk_bf16_f32 v154, v154, v154
    v_and_b32 v154, 0xffff, v154
    v_subrev_u32 v154, 0x4280, v154
    v_cmp_gt_u32 vcc, 0x80, v153
    s_nop 1
    v_cndmask_b32 v154, v154, v153, vcc
    v_lshlrev_b32 v154, 1, v154
    v_add_u32 v148, 0x27400, v154
    v_add_u32 v153, 2, v152
    v_cvt_f32_u32 v154, v153
    v_cvt_pk_bf16_f32 v154, v154, v154
    v_and_b32 v154, 0xffff, v154
    v_subrev_u32 v154, 0x4280, v154
    v_cmp_gt_u32 vcc, 0x80, v153
    s_nop 1
    v_cndmask_b32 v154, v154, v153, vcc
    v_lshlrev_b32 v154, 1, v154
    v_add_u32 v149, 0x27400, v154
    v_add_u32 v153, 1, v152
    v_cvt_f32_u32 v154, v153
    v_cvt_pk_bf16_f32 v154, v154, v154
    v_and_b32 v154, 0xffff, v154
    v_subrev_u32 v154, 0x4280, v154
    v_cmp_gt_u32 vcc, 0x80, v153
    s_nop 1
    v_cndmask_b32 v154, v154, v153, vcc
    v_lshlrev_b32 v154, 1, v154
    v_add_u32 v150, 0x27400, v154
    v_add_u32 v153, 0, v152
    v_cvt_f32_u32 v154, v153
    v_cvt_pk_bf16_f32 v154, v154, v154
    v_and_b32 v154, 0xffff, v154
    v_subrev_u32 v154, 0x4280, v154
    v_cmp_gt_u32 vcc, 0x80, v153
    s_nop 1
    v_cndmask_b32 v154, v154, v153, vcc
    v_lshlrev_b32 v154, 1, v154
    v_add_u32 v151, 0x27400, v154
    v_lshrrev_b32 v153, 4, v152
    v_lshlrev_b32 v153, 4, v153
    v_and_b32 v154, 1, v0
    v_mul_u32_u24 v154, 2304, v154
    v_add_u32 v153, v153, v154
    v_add_u32 v26, 0x25d00, v153
    v_lshrrev_b32 v153, 4, v0
    v_mul_u32_u24 v153, 2304, v153
    v_and_b32 v154, 15, v0
    v_lshlrev_b32 v154, 4, v154
    v_add_u32 v153, v153, v154
    v_add_u32 v27, 0x25c00, v153
    s_waitcnt lgkmcnt(0)
    s_mul_i32 s96, s96, 0x9E3779B1
    s_add_u32 s96, s96, 0x7F4A7C15
    s_barrier
    s_sub_u32 s10, s77, 28
    s_lshl_b32 s10, s10, 3
    s_add_u32 s10, s10, s3
    s_mul_i32 s11, s3, 10880
    s_cmp_ge_u32 s3, 3
    s_cselect_b32 s81, 0, 0
    s_add_u32 s11, s11, s81
    s_lshl_b32 s80, s76, 7
    s_add_u32 s8, s42, s80
    s_addc_u32 s9, s43, 0
    s_load_dwordx16 s[16:31], s[8:9], 0
    s_load_dwordx8 s[32:39], s[8:9], 64
    s_load_dwordx8 s[56:63], s[8:9], 96
    v_lshrrev_b32 v5, 3, v0
    v_and_b32 v6, 7, v0
    v_lshlrev_b32 v6, 4, v6
    v_lshlrev_b32 v7, 10, v5
    v_add_u32 v8, v7, v6
    s_lshl_b32 s12, s10, 16
    s_lshl_b32 s81, s76, 7
    s_add_u32 s12, s12, s81
    s_add_u32 m0, s11, 0
    s_add_u32 s13, s12, 0
    buffer_load_dwordx4 v8, s[52:55], s13 offen lds
    s_add_u32 m0, s11, 1056
    s_add_u32 s13, s12, 8192
    buffer_load_dwordx4 v8, s[52:55], s13 offen lds
    s_add_u32 m0, s11, 2112
    s_add_u32 s13, s12, 16384
    buffer_load_dwordx4 v8, s[52:55], s13 offen lds
    s_add_u32 m0, s11, 3168
    s_add_u32 s13, s12, 24576
    buffer_load_dwordx4 v8, s[52:55], s13 offen lds
    s_add_u32 m0, s11, 4224
    s_add_u32 s13, s12, 32768
    buffer_load_dwordx4 v8, s[52:55], s13 offen lds
    s_add_u32 m0, s11, 5280
    s_add_u32 s13, s12, 40960
    buffer_load_dwordx4 v8, s[52:55], s13 offen lds
    s_add_u32 m0, s11, 6336
    s_add_u32 s13, s12, 49152
    buffer_load_dwordx4 v8, s[52:55], s13 offen lds
    s_add_u32 m0, s11, 7392
    s_add_u32 s13, s12, 57344
    buffer_load_dwordx4 v8, s[52:55], s13 offen lds
    ds_read_u16 v64, v144 offset:0
    ds_read_u16 v65, v145 offset:0
    ds_read_u16 v66, v146 offset:0
    ds_read_u16 v67, v147 offset:0
    ds_read_u16 v68, v148 offset:0
    ds_read_u16 v69, v149 offset:0
    ds_read_u16 v70, v150 offset:0
    ds_read_u16 v71, v151 offset:0
    ds_read_u16 v72, v144 offset:1536
    ds_read_u16 v73, v145 offset:1536
    ds_read_u16 v74, v146 offset:1536
    ds_read_u16 v75, v147 offset:1536
    ds_read_u16 v76, v148 offset:1536
    ds_read_u16 v77, v149 offset:1536
    ds_read_u16 v78, v150 offset:1536
    ds_read_u16 v79, v151 offset:1536
    s_waitcnt lgkmcnt(0)
    v_lshl_or_b32 v52, v65, 16, v64
    v_lshl_or_b32 v53, v67, 16, v66
    v_lshl_or_b32 v54, v69, 16, v68
    v_lshl_or_b32 v55, v71, 16, v70
    v_lshl_or_b32 v56, v73, 16, v72
    v_lshl_or_b32 v57, v75, 16, v74
    v_lshl_or_b32 v58, v77, 16, v76
    v_lshl_or_b32 v59, v79, 16, v78
    v_mov_b32 v64, 0
    v_mov_b32 v65, 0
    v_mov_b32 v66, 0
    v_mov_b32 v67, 0
    v_mov_b32 v20, v26
    v_mov_b32 v21, v27
    v_lshrrev_b32 v5, 3, v0
    v_and_b32 v6, 7, v0
    v_lshlrev_b32 v6, 4, v6
    v_mul_u32_u24 v27, 160, v5
    v_add_u32 v27, v27, v6
    s_add_u32 s12, s11, 9504
    v_add_u32 v27, s12, v27
    v_mul_u32_u24 v5, 4224, v5
    v_add_u32 v30, v5, v6
    v_and_b32 v26, 3, v0
    v_lshrrev_b32 v5, 5, v0
    v_lshlrev_b32 v5, 2, v5
    v_add_u32 v26, v26, v5
    v_mul_u32_u24 v26, 1056, v26
    v_bfe_u32 v5, v0, 2, 2
    v_lshlrev_b32 v6, 7, v5
    v_add_u32 v26, v26, v6
    v_bfe_u32 v6, v0, 4, 1
    v_lshlrev_b32 v6, 3, v6
    v_add_u32 v26, v26, v6
    v_add_u32 v26, s11, v26
    v_bfe_u32 v5, v0, 4, 1
    v_lshlrev_b32 v5, 2, v5
    v_and_b32 v6, 3, v0
    v_add_u32 v5, v5, v6
    v_mul_u32_u24 v5, 160, v5
    v_bfe_u32 v6, v0, 2, 2
    v_lshlrev_b32 v6, 4, v6
    v_add_u32 v5, v5, v6
    v_lshrrev_b32 v6, 5, v0
    v_lshlrev_b32 v6, 6, v6
    v_add_u32 v28, v5, v6
    v_add_u32 v28, s12, v28
    s_mul_i32 s12, s76, 270336
    s_lshl_b32 s81, s10, 7
    s_add_u32 s12, s12, s81
    s_add_u32 s12, s12, 0x1400000
    v_lshrrev_b32 v5, 3, v0
    v_mul_u32_u24 v5, 1056, v5
    v_and_b32 v6, 7, v0
    v_lshlrev_b32 v6, 7, v6
    v_add_u32 v5, v5, v6
    v_add_u32 v22, s11, v5
    s_waitcnt vmcnt(0)
    ds_read_b64_tr_b16 v[64:65], v26 offset:0
    ds_read_b64_tr_b16 v[66:67], v26 offset:512
    ds_read_b64_tr_b16 v[68:69], v26 offset:16
    ds_read_b64_tr_b16 v[70:71], v26 offset:528
    ds_read_b64_tr_b16 v[72:73], v26 offset:32
    ds_read_b64_tr_b16 v[74:75], v26 offset:544
    s_waitcnt lgkmcnt(4)
    ds_write_b128 v28, v[64:67]
    ds_read_b128 a[0:3], v27
    ds_read_b64_tr_b16 v[76:77], v26 offset:48
    ds_read_b64_tr_b16 v[78:79], v26 offset:560
    s_waitcnt lgkmcnt(6)
    ds_write_b128 v28, v[68:71]
    ds_read_b128 a[4:7], v27
    ds_read_b64_tr_b16 v[80:81], v26 offset:64
    ds_read_b64_tr_b16 v[82:83], v26 offset:576
    s_waitcnt lgkmcnt(8)
    ds_write_b128 v28, v[72:75]
    ds_read_b128 a[8:11], v27
    s_add_u32 s13, s12, 0
    s_waitcnt lgkmcnt(8)
    buffer_store_dwordx4 a[0:3], v30, s[68:71], s13 offen sc1
    ds_read_b64_tr_b16 v[84:85], v26 offset:80
    ds_read_b64_tr_b16 v[86:87], v26 offset:592
    s_waitcnt lgkmcnt(8)
    ds_write_b128 v28, v[76:79]
    ds_read_b128 a[12:15], v27
    s_add_u32 s13, s12, 33792
    s_waitcnt lgkmcnt(8)
    buffer_store_dwordx4 a[4:7], v30, s[68:71], s13 offen sc1
    ds_read_b64_tr_b16 v[88:89], v26 offset:96
    ds_read_b64_tr_b16 v[90:91], v26 offset:608
    s_waitcnt lgkmcnt(8)
    ds_write_b128 v28, v[80:83]
    ds_read_b128 a[16:19], v27
    s_add_u32 s13, s12, 67584
    s_waitcnt lgkmcnt(8)
    buffer_store_dwordx4 a[8:11], v30, s[68:71], s13 offen sc1
    ds_read_b64_tr_b16 v[92:93], v26 offset:112
    ds_read_b64_tr_b16 v[94:95], v26 offset:624
    s_waitcnt lgkmcnt(8)
    ds_write_b128 v28, v[84:87]
    ds_read_b128 a[20:23], v27
    s_add_u32 s13, s12, 101376
    s_waitcnt lgkmcnt(8)
    buffer_store_dwordx4 a[12:15], v30, s[68:71], s13 offen sc1
    s_waitcnt lgkmcnt(6)
    ds_write_b128 v28, v[88:91]
    ds_read_b128 a[24:27], v27
    s_add_u32 s13, s12, 135168
    s_waitcnt lgkmcnt(6)
    buffer_store_dwordx4 a[16:19], v30, s[68:71], s13 offen sc1
    s_waitcnt lgkmcnt(4)
    ds_write_b128 v28, v[92:95]
    ds_read_b128 a[28:31], v27
    s_add_u32 s13, s12, 168960
    s_waitcnt lgkmcnt(4)
    buffer_store_dwordx4 a[20:23], v30, s[68:71], s13 offen sc1
    s_add_u32 s13, s12, 202752
    s_waitcnt lgkmcnt(2)
    buffer_store_dwordx4 a[24:27], v30, s[68:71], s13 offen sc1
    s_add_u32 s13, s12, 236544
    s_waitcnt lgkmcnt(0)
    buffer_store_dwordx4 a[28:31], v30, s[68:71], s13 offen sc1
    ds_read_b128 v[64:67], v22 offset:0
    ds_read_b128 v[68:71], v22 offset:16
    ds_read_b128 v[72:75], v22 offset:32
    ds_read_b128 v[76:79], v22 offset:48
    ds_read_b128 v[80:83], v22 offset:64
    ds_read_b128 v[84:87], v22 offset:80
    ds_read_b128 v[88:91], v22 offset:96
    ds_read_b128 v[92:95], v22 offset:112
    v_mov_b32 v24, 0
    v_mov_b32 v23, 0
    v_mov_b32 v25, s96
    s_waitcnt lgkmcnt(0)
    v_dot2_f32_bf16 v23, v64, s16, v23
    v_dot2_f32_bf16 v24, v65, s17, v24
    v_dot2_f32_bf16 v23, v66, s18, v23
    v_dot2_f32_bf16 v24, v67, s19, v24
    v_dot2_f32_bf16 v23, v68, s20, v23
    v_dot2_f32_bf16 v24, v69, s21, v24
    v_dot2_f32_bf16 v23, v70, s22, v23
    v_dot2_f32_bf16 v24, v71, s23, v24
    v_dot2_f32_bf16 v23, v72, s24, v23
    v_dot2_f32_bf16 v24, v73, s25, v24
    v_dot2_f32_bf16 v23, v74, s26, v23
    v_dot2_f32_bf16 v24, v75, s27, v24
    v_dot2_f32_bf16 v23, v76, s28, v23
    v_dot2_f32_bf16 v24, v77, s29, v24
    v_dot2_f32_bf16 v23, v78, s30, v23
    v_dot2_f32_bf16 v24, v79, s31, v24
    v_dot2_f32_bf16 v23, v80, s32, v23
    v_dot2_f32_bf16 v24, v81, s33, v24
    v_dot2_f32_bf16 v23, v82, s34, v23
    v_dot2_f32_bf16 v24, v83, s35, v24
    v_dot2_f32_bf16 v23, v84, s36, v23
    v_dot2_f32_bf16 v24, v85, s37, v24
    v_dot2_f32_bf16 v23, v86, s38, v23
    v_dot2_f32_bf16 v24, v87, s39, v24
    v_dot2_f32_bf16 v23, v88, s56, v23
    v_dot2_f32_bf16 v24, v89, s57, v24
    v_dot2_f32_bf16 v23, v90, s58, v23
    v_dot2_f32_bf16 v24, v91, s59, v24
    v_dot2_f32_bf16 v23, v92, s60, v23
    v_dot2_f32_bf16 v24, v93, s61, v24
    v_dot2_f32_bf16 v23, v94, s62, v23
    v_dot2_f32_bf16 v24, v95, s63, v24
    s_lshl_b32 s80, s76, 14
    s_lshl_b32 s81, s10, 9
    s_add_u32 s80, s80, s81
    s_add_u32 s80, s80, 0xea0000
    v_lshlrev_b32 v5, 3, v0
    v_add_f32 v24, v23, v24
    buffer_store_dwordx2 v[24:25], v5, s[68:71], s80 offen sc1
    s_lshl_b32 s80, s76, 9
    s_lshr_b32 s81, s10, 3
    s_lshl_b32 s81, s81, 7
    s_add_u32 s80, s80, s81
    s_lshl_b32 s81, s3, 2
    s_add_u32 s80, s80, s81
    s_add_u32 s15, s80, 0xe20000
    v_mov_b32 v26, v20
    v_mov_b32 v27, v21
    s_waitcnt vmcnt(0)
    v_mov_b32 v8, s96
    v_mov_b32 v9, 0
    s_mov_b64 exec, 1
    buffer_store_dword v8, v9, s[68:71], s15 offen sc1
    s_mov_b64 exec, -1
    v_mov_b32 v64, 0
    v_mov_b32 v65, 0
    v_mov_b32 v66, 0
    v_mov_b32 v67, 0
    s_barrier
    v_mov_b32 v16, 28928
    v_lshlrev_b32 v17, 2, v0
    v_add_u32 v17, v16, v17
    v_mov_b32 v18, 0
    v_mov_b32 v19, 1
    ds_write_b32 v17, v18
    s_waitcnt lgkmcnt(0)
    s_barrier
    ds_write_b128 v27, v[64:67]
    ds_write_b128 v26, v[52:55] offset:0
    ds_write_b128 v26, v[56:59] offset:4608
    s_mul_i32 s85, s79, 4224
    s_and_b32 s81, s78, 1
    s_lshl_b32 s80, s81, 11
    s_add_u32 s85, s85, s80
    s_add_u32 s85, s85, 0x1400000
    s_lshr_b32 s82, s78, 1
    s_mul_i32 s83, s82, 4352
    s_add_u32 s83, s83, 16640
    s_add_u32 s86, s83, s80
    s_add_u32 s86, s86, 64
    v_lshlrev_b32 v28, 2, v0
    v_add_u32 v22, s83, v28
    s_lshl_b32 s80, s81, 8
    s_add_u32 s80, s80, s83
    s_add_u32 s80, s80, 28
    v_add_u32 v28, s80, v28
    s_lshl_b32 s81, s81, 10
    s_mul_i32 s80, s82, 33536
    s_add_u32 s80, s80, 98304
    s_add_u32 s80, s80, s81
    v_lshlrev_b32 v20, 4, v0
    v_add_u32 v21, s80, v20
    s_mul_i32 s80, s82, 114944
    s_sub_u32 s80, 115072, s80
    s_add_u32 s80, s80, s81
    v_add_u32 v20, s80, v20
    v_lshrrev_b32 v5, 3, v0
    v_lshlrev_b32 v5, 10, v5
    v_bfe_u32 v6, v0, 4, 1
    v_lshlrev_b32 v6, 2, v6
    v_and_b32 v7, 7, v0
    v_xor_b32 v6, v6, v7
    v_lshlrev_b32 v6, 4, v6
    v_add_u32 v30, v5, v6
    s_mul_i32 s94, s78, 458752
    s_lshl_b32 s80, s98, 7
    s_add_u32 s94, s94, s80
    s_mov_b32 s18, 0
    s_mov_b32 s19, 1
    s_mov_b32 s20, 2
    s_mov_b32 s21, 3
    s_mov_b32 s22, 4
    s_mov_b32 s23, 5
    s_mov_b32 s24, 6
    s_lshl_b32 s95, s78, 14
    s_add_u32 s95, s95, 32768
    s_lshl_b32 s25, s78, 13
    s_lshr_b32 s80, s78, 1
    s_and_b32 s82, s78, 1
    s_mul_i32 s81, s80, 33536
    s_add_u32 s81, s81, 98304
    s_mul_i32 s83, s80, 114944
    s_sub_u32 s83, 115072, s83
    v_bfe_u32 v5, v0, 4, 1
    v_lshlrev_b32 v5, 1, v5
    v_lshrrev_b32 v6, 5, v0
    v_add_u32 v5, v5, v6
    v_bfe_u32 v6, v0, 1, 3
    v_lshlrev_b32 v7, 2, v5
    v_sub_u32 v7, v6, v7
    v_add_u32 v7, 13, v7
    v_lshlrev_b32 v7, 4, v7
    v_mov_b32 v8, s81
    v_mov_b32 v9, s83
    v_and_b32 v6, 1, v0
    v_cmp_eq_u32 vcc, 1, v6
    s_nop 1
    v_cndmask_b32 v8, v8, v9, vcc
    v_add_u32 v8, v8, v7
    s_lshl_b32 s81, s82, 10
    v_add_u32 v8, s81, v8
    v_and_b32 v6, 15, v0
    v_lshrrev_b32 v7, 5, v0
    v_mul_u32_u24 v7, 2304, v7
    v_bfe_u32 v9, v0, 4, 1
    v_add_u32 v9, v9, v6
    v_lshlrev_b32 v9, 4, v9
    v_add_u32 v7, v7, v9
    s_mul_i32 s81, s80, 4608
    s_lshl_b32 s83, s82, 7
    s_sub_u32 s83, s81, s83
    s_add_u32 s83, s83, 154768
    v_add_u32 v9, s83, v7
    v_lshlrev_b32 v10, 4, v0
    s_lshl_b32 s81, s78, 12
    s_add_u32 s81, s81, 16640
    s_cmp_eq_u32 s78, 3
    s_cselect_b32 s81, 148480, s81
    v_add_u32 v12, s81, v10
    s_xor_b32 s83, s78, 1
    s_lshl_b32 s81, s83, 12
    s_add_u32 s81, s81, 16640
    s_cmp_eq_u32 s83, 3
    s_cselect_b32 s81, 148480, s81
    v_add_u32 v11, s81, v10
    v_and_b32 v15, 15, v0
    v_lshlrev_b32 v15, 5, v15
    v_lshrrev_b32 v14, 4, v0
    v_lshlrev_b32 v14, 3, v14
    v_add_u32 v15, v15, v14
    s_lshl_b32 s81, s78, 12
    s_add_u32 s81, s81, 0
    v_add_u32 v15, s81, v15
    v_add_u32 v14, s81, v10
    s_lshl_b32 s84, s76, 9
    s_add_u32 s84, s84, 0xe20000
    v_bfe_u32 v24, v0, 3, 2
    v_lshlrev_b32 v24, 7, v24
    v_and_b32 v25, 7, v0
    v_lshlrev_b32 v25, 2, v25
    v_add_u32 v24, v24, v25
    s_mov_b32 s99, 0x40000
Lp_3001:
    buffer_load_dword v25, v24, s[68:71], s84 offen sc1
    s_waitcnt vmcnt(0)
    v_cmp_ne_u32 vcc, s96, v25
    s_nop 4
    s_cmp_eq_u64 vcc, 0
    s_cbranch_scc1 Lpd_3002
    s_sleep 8
    s_sub_u32 s99, s99, 1
    s_cmp_lg_u32 s99, 0
    s_cbranch_scc1 Lp_3001
Lpd_3002:
    s_mov_b32 m0, s86
    s_nop 0
    buffer_load_dwordx4 v10, s[68:71], s85 offen offset:0 sc1 lds
    s_mov_b32 m0, s86
    s_nop 0
    buffer_load_dwordx4 v10, s[68:71], s85 offen offset:1024 sc1 lds
    v_mov_b32 v23, 0
    s_mov_b64 exec, 0xffff
    ds_write_b32 v22, v23
    s_mov_b64 exec, -1
    s_barrier
    s_waitcnt vmcnt(0) lgkmcnt(0)
    s_branch Lh8
Lcodeend:
.section .rodata,"a"
.p2align 6
.amdhsa_kernel gated_mix__ssm_conv_s4__geglu_ffn__prompt_kernel
  .amdhsa_next_free_vgpr 256
  .amdhsa_next_free_sgpr 100
  .amdhsa_accum_offset 160
  .amdhsa_group_segment_fixed_size 0
  .amdhsa_kernarg_size 136
  .amdhsa_user_sgpr_count 2
  .amdhsa_user_sgpr_kernarg_segment_ptr 1
  .amdhsa_system_sgpr_workgroup_id_x 1
  .amdhsa_float_denorm_mode_32 3
.end_amdhsa_kernel
```
